```python
import torch

def _softmax(x, axis=-1):
    return torch.softmax(x, dim=axis)
def _gelu(x):
    return torch.nn.functional.gelu(x, approximate="tanh")
def _silu(x):
    return torch.nn.functional.silu(x)
def _sigmoid(x):
    return torch.sigmoid(x)
def _layernorm(x, axis=-1, eps=1e-5):
    m = x.mean(dim=axis, keepdim=True)
    v = x.var(dim=axis, keepdim=True, unbiased=False)
    return (x - m) / torch.sqrt(v + eps)
def _scatter_add(tgt, idx, src, axis=0):
    return tgt.clone().index_add_(axis, idx, src)
def _segment_sum(src, seg, n):
    out = torch.zeros((n,) + src.shape[1:], dtype=src.dtype)
    return out.index_add_(0, seg, src)
def _pad(x, pw):
    flat = tuple(v for pair in reversed(pw) for v in pair)
    return torch.nn.functional.pad(x, flat)

kernel_name = 'recurrent_scan__linear_kernel_hedgehog__dense_activation_squared_relu__prompt'

def setup_inputs():

    _w = (lambda a: (lambda t: t.to(torch.bfloat16) if t.is_floating_point() else t)(torch.as_tensor(a)))
    def _A_setup():
        B, S, D, H = 1, 2048, 512, 32
        Dh = D // H
        return {
            "x": _w((lambda *s: torch.randn(*s, dtype=torch.bfloat16) * 0.05)(B, S, D)),
            "wqkv": _w((lambda *s: torch.randn(*s, dtype=torch.bfloat16) * 0.2)(D, 3 * D)),
            "w_phi": _w((lambda *s: torch.randn(*s, dtype=torch.bfloat16) * 0.2)(H, Dh, Dh) * (Dh ** -0.5)),
            "wo": _w((lambda *s: torch.randn(*s, dtype=torch.bfloat16) * 0.05)(D, D)),
        }
    _A_in = _A_setup()

    def _B_setup():
        B, S, D, F = 1, 2048, 512, 1792
        return {
            "x": _w((lambda *s: torch.randn(*s, dtype=torch.bfloat16) * 0.05)(B, S, D)),
            "w1": _w((lambda *s: torch.randn(*s, dtype=torch.bfloat16) * 0.05)(D, F)),
            "b1": _w((lambda *s: torch.randn(*s, dtype=torch.bfloat16) * 0.2)(F)),
            "w2": _w((lambda *s: torch.randn(*s, dtype=torch.bfloat16) * 0.05)(F, D)),
            "b2": _w((lambda *s: torch.randn(*s, dtype=torch.bfloat16) * 0.8)(D)),
        }
    _B_in = _B_setup()

    return {
        "A_x": _A_in["x"],
        "A_wqkv": _A_in["wqkv"],
        "A_w_phi": _A_in["w_phi"],
        "A_wo": _A_in["wo"],
        "B_x": _B_in["x"],
        "B_w1": _B_in["w1"],
        "B_b1": _B_in["b1"],
        "B_w2": _B_in["w2"],
        "B_b2": _B_in["b2"],
    }

def reference(A_x, A_wqkv, A_w_phi, A_wo, B_x, B_w1, B_b1, B_w2, B_b2):
    def _A_ref(x, wqkv, w_phi, wo):
        B, S, D = x.shape
        H = 32; Dh = D // H
        qkv = (lambda x, *d: x.permute(*d))((x @ wqkv).reshape(B, S, 3, H, Dh), 2, 0, 3, 1, 4)
        q, k, v = qkv[0], qkv[1], qkv[2]
        pq = torch.einsum("bhsd,hdf->bhsf", q, w_phi)
        pk = torch.einsum("bhsd,hdf->bhsf", k, w_phi)
        phi_q = torch.concatenate([_softmax(pq, axis=-1), _softmax(-pq, axis=-1)], axis=-1)
        phi_k = torch.concatenate([_softmax(pk, axis=-1), _softmax(-pk, axis=-1)], axis=-1)
        kv = torch.einsum("bhsf,bhsd->bhfd", phi_k, v)
        z  = torch.einsum("bhsf->bhf", phi_k)
        num = torch.einsum("bhqf,bhfd->bhqd", phi_q, kv)
        den = torch.einsum("bhqf,bhf->bhq", phi_q, z)[..., None] + 1e-6
        o = num / den
        return (lambda x, *d: x.permute(*d))(o, 0, 2, 1, 3).reshape(B, S, D) @ wo

    def _B_ref(x, w1, b1, w2, b2):
        h = torch.einsum("bsd,df->bsf", x, w1) + b1
        zero = torch.zeros_like(h)
        r = torch.where(h > zero, h, zero)
        h = r * r
        out = torch.einsum("bsf,fd->bsd", h, w2) + b2
        return out

    x = A_x
    xn = _layernorm(x, axis=-1)
    s = _A_ref(xn, A_wqkv, A_w_phi, A_wo)
    g = _silu(_B_ref(xn, B_w1, B_b1, B_w2, B_b2))
    return x + s * g
```

```asm
; @launch kernel=k1_kernel grid=(256,1,1) block=(512,1,1) lds=153600
; @launch kernel=k2_kernel grid=(256,1,1) block=(512,1,1) lds=124928
.amdgcn_target "amdgcn-amd-amdhsa--gfx950"
.text
.globl k1_kernel
.p2align 8
.type k1_kernel,@function
k1_kernel:
    s_cmp_ge_u32 s2, 256
    s_cbranch_scc1 K1_END
    s_load_dwordx4 s[4:7], s[0:1], 0
    s_load_dwordx4 s[8:11], s[0:1], 16
    s_load_dwordx4 s[12:15], s[0:1], 40
    s_load_dwordx2 s[16:17], s[0:1], 88
    s_load_dwordx2 s[18:19], s[0:1], 56

    s_getpc_b64 s[50:51]
K1_PCREF:
    s_sub_u32 s50, s50, K1_PCREF-k1_kernel
    s_subb_u32 s51, s51, 0
    v_lshlrev_b32 v4, 7, v0
    v_min_u32 v4, CODE_END-k1_kernel-4, v4
    global_load_dword v255, v4, s[50:51]

    v_lshrrev_b32 v4, 6, v0
    v_and_b32 v1, 63, v0
    v_and_b32 v2, 15, v0
    v_bfe_u32 v3, v0, 4, 2
    v_readfirstlane_b32 s46, v4
    s_and_b32 s50, s2, 7
    s_lshr_b32 s51, s2, 3
    s_and_b32 s52, s50, 1
    s_lshl_b32 s52, s52, 3
    s_and_b32 s53, s51, 7
    s_add_u32 s44, s52, s53
    s_lshr_b32 s52, s50, 1
    s_lshl_b32 s52, s52, 2
    s_lshr_b32 s53, s51, 3
    s_add_u32 s45, s52, s53
    s_and_b32 s43, s45, 1
    s_and_b32 s47, s46, 3
    s_lshr_b32 s48, s46, 2
    s_mov_b32 s55, 0x3fb8aa3b
    v_lshlrev_b32 v37, 4, v1
    s_lshl_b32 s54, s46, 11

    s_lshl_b32 s50, s44, 7
    s_lshl_b32 s51, s46, 4
    s_add_u32 s50, s50, s51
    v_lshrrev_b32 v4, 3, v1
    v_add_u32 v4, s50, v4
    v_lshlrev_b32 v4, 10, v4
    v_and_b32 v5, 7, v1
    v_xor_b32 v6, v5, v3
    v_lshl_add_u32 v10, v6, 4, v4
    v_xor_b32 v6, 4, v6
    v_lshl_add_u32 v11, v6, 4, v4
    v_add_u32 v11, 0x2000, v11

    s_and_b32 s50, s46, 1
    s_lshl_b32 s50, s50, 2
    v_or_b32 v4, s50, v3
    v_lshlrev_b32 v4, 1, v4
    v_xor_b32 v4, v4, v2
    s_lshl_b32 s51, s46, 3
    v_add_u32 v5, s51, v3
    v_lshrrev_b32 v6, 2, v4
    v_min_u32 v6, 2, v6
    v_and_b32 v7, 3, v4
    v_lshlrev_b32 v6, 10, v6
    v_lshl_add_u32 v6, v7, 4, v6
    v_mul_u32_u24 v7, 3072, v5
    s_lshl_b32 s51, s45, 6
    v_add3_u32 v12, v6, v7, s51
    v_add_u32 v13, 12288, v12
    v_min_u32 v6, 13, v4
    s_lshl_b32 s50, s43, 1
    v_add_u32 v6, s50, v6
    v_subrev_u32 v7, 14, v6
    v_min_u32 v6, v6, v7
    v_mul_u32_u24 v7, 3584, v5
    s_mul_i32 s51, s45, 224
    v_lshl_add_u32 v6, v6, 4, v7
    v_add_u32 v14, s51, v6
    v_add_u32 v15, 14336, v14

    s_and_b32 s50, s2, 7
    s_lshr_b32 s51, s2, 3
    s_and_b32 s52, s50, 1
    s_lshl_b32 s52, s52, 10
    s_lshl_b32 s53, s51, 5
    s_add_u32 s52, s52, s53
    s_lshr_b32 s53, s47, 1
    s_lshl_b32 s53, s53, 4
    s_add_u32 s52, s52, s53
    v_add_u32 v4, s52, v2
    v_lshlrev_b32 v4, 10, v4
    s_lshr_b32 s50, s50, 1
    v_lshrrev_b32 v5, 3, v2
    s_lshl_b32 s52, s51, 1
    v_add_u32 v5, s52, v5
    v_and_b32 v6, 7, v2
    v_min_u32 v7, 5, v6
    v_lshrrev_b32 v8, 1, v7
    v_and_b32 v7, 1, v7
    v_lshlrev_b32 v8, 10, v8
    v_lshl_add_u32 v8, v7, 7, v8
    v_mul_u32_u24 v7, 3072, v5
    s_lshl_b32 s52, s50, 8
    v_add3_u32 v7, v7, v8, s52
    v_min_u32 v6, 6, v6
    v_mul_u32_u24 v8, 3584, v5
    v_lshl_add_u32 v8, v6, 7, v8
    s_mul_i32 s52, s50, 896
    v_add_u32 v8, s52, v8
    s_cmp_eq_u32 s47, 1
    s_cselect_b64 s[52:53], -1, 0
    s_cmp_eq_u32 s47, 2
    s_cselect_b64 s[50:51], -1, 0
    v_cndmask_b32 v4, v4, v7, s[52:53]
    v_cndmask_b32 v254, v4, v8, s[50:51]
    s_movk_i32 s62, 128
    s_cmp_eq_u32 s47, 1
    s_cselect_b32 s62, 196608, s62
    s_cmp_eq_u32 s47, 2
    s_cselect_b32 s62, 229376, s62
    s_mul_i32 s63, s62, s48

    s_waitcnt lgkmcnt(0)
    s_mov_b32 s20, s4
    s_and_b32 s21, s5, 0xffff
    s_mov_b32 s22, 2097152
    s_mov_b32 s23, 0x20000

    s_mov_b32 s24, s6
    s_and_b32 s25, s7, 0xffff
    s_mov_b32 s26, 1572864
    s_mov_b32 s27, 0x20000

    s_mov_b32 s28, s12
    s_and_b32 s29, s13, 0xffff
    s_mov_b32 s30, 1835008
    s_mov_b32 s31, 0x20000

    s_cmp_eq_u32 s47, 1
    s_cselect_b32 s76, s24, s20
    s_cselect_b32 s77, s25, s21
    s_cselect_b32 s78, s26, s22
    s_cmp_eq_u32 s47, 2
    s_cselect_b32 s76, s28, s76
    s_cselect_b32 s77, s29, s77
    s_cselect_b32 s78, s30, s78
    s_mov_b32 s79, 0x20000
    buffer_load_dword v255, v254, s[76:79], s63 offen

    s_movk_i32 s57, 0
    s_add_u32 m0, s54, 0
    s_nop 0
    buffer_load_dwordx4 v10, s[20:23], s57 offen lds
    s_add_u32 m0, s54, 1024
    s_nop 0
    buffer_load_dwordx4 v11, s[20:23], s57 offen lds
    s_mov_b32 s58, 0
    s_add_u32 m0, s54, 49152
    s_nop 0
    buffer_load_dwordx4 v12, s[24:27], s58 offen lds
    s_add_u32 m0, s54, 50176
    s_nop 0
    buffer_load_dwordx4 v13, s[24:27], s58 offen lds
    s_mov_b32 s59, 0
    s_add_u32 m0, s54, 98304
    s_nop 0
    buffer_load_dwordx4 v14, s[28:31], s59 offen lds
    s_add_u32 m0, s54, 99328
    s_nop 0
    buffer_load_dwordx4 v15, s[28:31], s59 offen lds
    s_barrier
    s_movk_i32 s57, 128
    s_add_u32 m0, s54, 16384
    s_nop 0
    buffer_load_dwordx4 v10, s[20:23], s57 offen lds
    s_add_u32 m0, s54, 17408
    s_nop 0
    buffer_load_dwordx4 v11, s[20:23], s57 offen lds
    s_mov_b32 s58, 196608
    s_add_u32 m0, s54, 65536
    s_nop 0
    buffer_load_dwordx4 v12, s[24:27], s58 offen lds
    s_add_u32 m0, s54, 66560
    s_nop 0
    buffer_load_dwordx4 v13, s[24:27], s58 offen lds
    s_mov_b32 s59, 229376
    s_add_u32 m0, s54, 114688
    s_nop 0
    buffer_load_dwordx4 v14, s[28:31], s59 offen lds
    s_add_u32 m0, s54, 115712
    s_nop 0
    buffer_load_dwordx4 v15, s[28:31], s59 offen lds
    s_mov_b32 s32, s16
    s_and_b32 s33, s17, 0xffff
    s_mov_b32 s34, 16777216
    s_mov_b32 s35, 0x20000

    s_mov_b32 s36, s14
    s_and_b32 s37, s15, 0xffff
    s_mov_b32 s38, 3584
    s_mov_b32 s39, 0x20000

    s_mov_b32 s64, s8
    s_and_b32 s65, s9, 0xffff
    s_mov_b32 s66, 16384
    s_mov_b32 s67, 0x20000

    s_mov_b32 s68, s18
    s_and_b32 s69, s19, 0xffff
    s_mov_b32 s70, 1835008
    s_mov_b32 s71, 0x20000

    s_mov_b32 s72, s10
    s_and_b32 s73, s11, 0xffff
    s_mov_b32 s74, 524288
    s_mov_b32 s75, 0x20000

    s_mov_b32 m0, 147456
    s_lshl_b32 s51, s45, 10
    buffer_load_dwordx4 v37, s[64:67], s51 offen lds
    s_lshl_b32 s50, s2, 8
    s_add_u32 s50, s50, 14680064
    v_lshlrev_b32 v4, 2, v1
    v_mov_b32 v5, -1
    buffer_store_dword v5, v4, s[32:35], s50 offen

    v_lshrrev_b32 v4, 1, v2
    v_xor_b32 v4, v4, v3
    v_lshlrev_b32 v4, 4, v4
    s_lshl_b32 s50, s47, 5
    s_lshl_b32 s51, s48, 4
    s_add_u32 s51, s51, s50
    v_add_u32 v5, s51, v2
    v_lshl_add_u32 v16, v5, 7, v4
    v_xor_b32 v17, 64, v16
    v_xor_b32 v18, 0x800, v16
    v_xor_b32 v19, 0x800, v17
    v_lshlrev_b32 v4, 3, v5
    v_add_u32 v33, 148480, v4
    v_xor_b32 v35, 0x80, v33
    s_lshl_b32 s50, s47, 6
    s_lshl_b32 s51, s48, 9
    s_add_u32 s51, s51, 149504
    s_add_u32 s50, s50, s51
    v_lshlrev_b32 v4, 4, v3
    v_add_u32 v34, s50, v4
    v_add_u32 v36, s51, v4
    v_lshrrev_b32 v4, 2, v2
    v_and_b32 v5, 1, v3
    v_lshl_or_b32 v5, v5, 2, v4
    v_lshlrev_b32 v5, 5, v5
    v_lshl_add_u32 v6, v3, 3, v4
    v_lshl_add_u32 v5, v6, 8, v5
    v_and_b32 v6, 3, v2
    v_lshl_add_u32 v5, v6, 3, v5
    s_mul_i32 s50, s48, 49152
    s_add_u32 s50, s50, 49152
    v_add_u32 v232, s50, v5

    v_xor_b32 v233, 32, v232
    v_xor_b32 v234, 64, v232
    v_xor_b32 v235, 96, v232
    v_xor_b32 v236, 128, v232
    v_xor_b32 v237, 160, v232
    v_xor_b32 v238, 192, v232
    v_mov_b32 v136, 0
    v_mov_b32 v137, 0
    v_mov_b32 v138, 0
    v_mov_b32 v139, 0
    v_mov_b32 v140, 0
    v_mov_b32 v141, 0
    v_mov_b32 v142, 0
    v_mov_b32 v143, 0
    v_mov_b32 v144, 0
    v_mov_b32 v145, 0
    v_mov_b32 v146, 0
    v_mov_b32 v147, 0
    v_mov_b32 v148, 0
    v_mov_b32 v149, 0
    v_mov_b32 v150, 0
    v_mov_b32 v151, 0
    v_mov_b32 v152, 0
    v_mov_b32 v153, 0
    v_mov_b32 v154, 0
    v_mov_b32 v155, 0
    v_mov_b32 v156, 0
    v_mov_b32 v157, 0
    v_mov_b32 v158, 0
    v_mov_b32 v159, 0
    v_mov_b32 v160, 0
    v_mov_b32 v161, 0
    v_mov_b32 v162, 0
    v_mov_b32 v163, 0
    v_mov_b32 v164, 0
    v_mov_b32 v165, 0
    v_mov_b32 v166, 0
    v_mov_b32 v167, 0
    v_mov_b32 v168, 0
    v_mov_b32 v169, 0
    v_mov_b32 v170, 0
    v_mov_b32 v171, 0
    v_mov_b32 v172, 0
    v_mov_b32 v173, 0
    v_mov_b32 v174, 0
    v_mov_b32 v175, 0
    v_mov_b32 v176, 0
    v_mov_b32 v177, 0
    v_mov_b32 v178, 0
    v_mov_b32 v179, 0
    v_mov_b32 v180, 0
    v_mov_b32 v181, 0
    v_mov_b32 v182, 0
    v_mov_b32 v183, 0
    v_mov_b32 v184, 0
    v_mov_b32 v185, 0
    v_mov_b32 v186, 0
    v_mov_b32 v187, 0
    v_mov_b32 v188, 0
    v_mov_b32 v189, 0
    v_mov_b32 v190, 0
    v_mov_b32 v191, 0
    v_mov_b32 v192, 0
    v_mov_b32 v193, 0
    v_mov_b32 v194, 0
    v_mov_b32 v195, 0
    v_mov_b32 v196, 0
    v_mov_b32 v197, 0
    v_mov_b32 v198, 0
    v_mov_b32 v199, 0
    v_mov_b32 v200, 0
    v_mov_b32 v201, 0
    v_mov_b32 v202, 0
    v_mov_b32 v203, 0
    v_mov_b32 v204, 0
    v_mov_b32 v205, 0
    v_mov_b32 v206, 0
    v_mov_b32 v207, 0
    v_mov_b32 v208, 0
    v_mov_b32 v209, 0
    v_mov_b32 v210, 0
    v_mov_b32 v211, 0
    v_mov_b32 v212, 0
    v_mov_b32 v213, 0
    v_mov_b32 v214, 0
    v_mov_b32 v215, 0
    v_mov_b32 v216, 0
    v_mov_b32 v217, 0
    v_mov_b32 v218, 0
    v_mov_b32 v219, 0
    v_mov_b32 v220, 0
    v_mov_b32 v221, 0
    v_mov_b32 v222, 0
    v_mov_b32 v223, 0
    v_mov_b32 v224, 0
    v_mov_b32 v225, 0
    v_mov_b32 v226, 0
    v_mov_b32 v227, 0
    v_mov_b32 v228, 0x3f803f80
    v_mov_b32 v229, 0x3f803f80
    v_mov_b32 v230, 0x3f803f80
    v_mov_b32 v231, 0x3f803f80
    v_lshl_add_u32 v8, v3, 2, 0
    v_lshrrev_b32 v9, 2, v2
    v_add_u32 v8, v8, v9
    v_lshlrev_b32 v8, 5, v8
    v_and_b32 v9, 3, v2
    v_lshl_add_u32 v8, v9, 3, v8
    v_add_u32 v38, 147456, v8
    s_lshl_b32 s42, s44, 3
    s_lshl_b32 s50, s47, 1
    s_add_u32 s42, s42, s50

    s_cmp_eq_u32 s48, 1
    s_cbranch_scc1 K1_HPATH
    s_mul_i32 s63, s62, 2
    buffer_load_dword v255, v254, s[76:79], s63 offen
    s_mul_i32 s63, s62, 3
    buffer_load_dword v255, v254, s[76:79], s63 offen
    s_waitcnt vmcnt(10)
    s_barrier
    ds_read_b128 v[64:67], v16 offset:0
    ds_read_b128 v[68:71], v18 offset:0
    ds_read_b64_tr_b16 v[72:73], v232 offset:0
    ds_read_b64_tr_b16 v[74:75], v232 offset:1024
    ds_read_b64_tr_b16 v[76:77], v233 offset:0
    ds_read_b64_tr_b16 v[78:79], v233 offset:1024
    ds_read_b64_tr_b16 v[80:81], v234 offset:0
    ds_read_b64_tr_b16 v[82:83], v234 offset:1024
    ds_read_b64_tr_b16 v[84:85], v235 offset:0
    ds_read_b64_tr_b16 v[86:87], v235 offset:1024
    ds_read_b64_tr_b16 v[88:89], v236 offset:0
    ds_read_b64_tr_b16 v[90:91], v236 offset:1024
    ds_read_b64_tr_b16 v[92:93], v237 offset:0
    ds_read_b64_tr_b16 v[94:95], v237 offset:1024
    s_waitcnt lgkmcnt(0)
    v_mfma_f32_16x16x32_bf16 v[136:139], v[72:75], v[64:67], v[136:139]
    ds_read_b128 v[100:103], v17 offset:0
    ds_read_b128 v[104:107], v19 offset:0
    v_mfma_f32_16x16x32_bf16 v[140:143], v[72:75], v[68:71], v[140:143]
    ds_read_b64_tr_b16 v[108:109], v232 offset:8192
    ds_read_b64_tr_b16 v[110:111], v232 offset:9216
    v_mfma_f32_16x16x32_bf16 v[144:147], v[76:79], v[64:67], v[144:147]
    ds_read_b64_tr_b16 v[112:113], v233 offset:8192
    ds_read_b64_tr_b16 v[114:115], v233 offset:9216
    v_mfma_f32_16x16x32_bf16 v[148:151], v[76:79], v[68:71], v[148:151]
    ds_read_b64_tr_b16 v[116:117], v234 offset:8192
    ds_read_b64_tr_b16 v[118:119], v234 offset:9216
    v_mfma_f32_16x16x32_bf16 v[152:155], v[80:83], v[64:67], v[152:155]
    ds_read_b64_tr_b16 v[120:121], v235 offset:8192
    ds_read_b64_tr_b16 v[122:123], v235 offset:9216
    v_mfma_f32_16x16x32_bf16 v[156:159], v[80:83], v[68:71], v[156:159]
    ds_read_b64_tr_b16 v[124:125], v236 offset:8192
    ds_read_b64_tr_b16 v[126:127], v236 offset:9216
    v_mfma_f32_16x16x32_bf16 v[160:163], v[84:87], v[64:67], v[160:163]
    ds_read_b64_tr_b16 v[128:129], v237 offset:8192
    ds_read_b64_tr_b16 v[130:131], v237 offset:9216
    v_mfma_f32_16x16x32_bf16 v[164:167], v[84:87], v[68:71], v[164:167]
    s_movk_i32 s57, 256
    s_add_u32 m0, s54, 32768
    s_nop 0
    buffer_load_dwordx4 v10, s[20:23], s57 offen lds
    s_add_u32 m0, s54, 33792
    s_nop 0
    buffer_load_dwordx4 v11, s[20:23], s57 offen lds
    v_mfma_f32_16x16x32_bf16 v[168:171], v[88:91], v[64:67], v[168:171]
    s_mov_b32 s58, 393216
    s_add_u32 m0, s54, 81920
    s_nop 0
    buffer_load_dwordx4 v12, s[24:27], s58 offen lds
    s_add_u32 m0, s54, 82944
    s_nop 0
    buffer_load_dwordx4 v13, s[24:27], s58 offen lds
    v_mfma_f32_16x16x32_bf16 v[172:175], v[88:91], v[68:71], v[172:175]
    s_mov_b32 s59, 458752
    s_add_u32 m0, s54, 131072
    s_nop 0
    buffer_load_dwordx4 v14, s[28:31], s59 offen lds
    s_add_u32 m0, s54, 132096
    s_nop 0
    buffer_load_dwordx4 v15, s[28:31], s59 offen lds
    v_mfma_f32_16x16x32_bf16 v[176:179], v[92:95], v[64:67], v[176:179]
    s_mul_i32 s63, s62, 4
    buffer_load_dword v255, v254, s[76:79], s63 offen
    v_mfma_f32_16x16x32_bf16 v[180:183], v[92:95], v[68:71], v[180:183]
    v_mfma_f32_16x16x32_bf16 v[192:195], v[228:231], v[64:67], v[192:195]
    v_mfma_f32_16x16x32_bf16 v[196:199], v[64:67], v[64:67], v[196:199]
    s_waitcnt vmcnt(11) lgkmcnt(0)
    s_barrier
    s_cmp_lg_u32 s47, 0
    s_cbranch_scc1 K1_CS_0_0_1
    v_mfma_f32_16x16x32_bf16 v[200:203], v[72:75], v[228:231], v[200:203]
    v_mfma_f32_16x16x32_bf16 v[204:207], v[88:91], v[228:231], v[204:207]
    v_mfma_f32_16x16x32_bf16 v[200:203], v[108:111], v[228:231], v[200:203]
    v_mfma_f32_16x16x32_bf16 v[204:207], v[124:127], v[228:231], v[204:207]
    s_branch K1_CS_0_0_e
K1_CS_0_0_1:
    s_cmp_lg_u32 s47, 1
    s_cbranch_scc1 K1_CS_0_0_2
    v_mfma_f32_16x16x32_bf16 v[200:203], v[76:79], v[228:231], v[200:203]
    v_mfma_f32_16x16x32_bf16 v[204:207], v[92:95], v[228:231], v[204:207]
    v_mfma_f32_16x16x32_bf16 v[200:203], v[112:115], v[228:231], v[200:203]
    v_mfma_f32_16x16x32_bf16 v[204:207], v[128:131], v[228:231], v[204:207]
    s_branch K1_CS_0_0_e
K1_CS_0_0_2:
    s_cmp_lg_u32 s47, 2
    s_cbranch_scc1 K1_CS_0_0_3
    v_mfma_f32_16x16x32_bf16 v[200:203], v[80:83], v[228:231], v[200:203]
    v_mfma_f32_16x16x32_bf16 v[200:203], v[116:119], v[228:231], v[200:203]
    s_branch K1_CS_0_0_e
K1_CS_0_0_3:
    v_mfma_f32_16x16x32_bf16 v[200:203], v[84:87], v[228:231], v[200:203]
    v_mfma_f32_16x16x32_bf16 v[200:203], v[120:123], v[228:231], v[200:203]
K1_CS_0_0_e:
    v_mfma_f32_16x16x32_bf16 v[136:139], v[108:111], v[100:103], v[136:139]
    ds_read_b128 v[64:67], v16 offset:16384
    ds_read_b128 v[68:71], v18 offset:16384
    v_mfma_f32_16x16x32_bf16 v[140:143], v[108:111], v[104:107], v[140:143]
    ds_read_b64_tr_b16 v[72:73], v232 offset:16384
    ds_read_b64_tr_b16 v[74:75], v232 offset:17408
    v_mfma_f32_16x16x32_bf16 v[144:147], v[112:115], v[100:103], v[144:147]
    ds_read_b64_tr_b16 v[76:77], v233 offset:16384
    ds_read_b64_tr_b16 v[78:79], v233 offset:17408
    v_mfma_f32_16x16x32_bf16 v[148:151], v[112:115], v[104:107], v[148:151]
    ds_read_b64_tr_b16 v[80:81], v234 offset:16384
    ds_read_b64_tr_b16 v[82:83], v234 offset:17408
    v_mfma_f32_16x16x32_bf16 v[152:155], v[116:119], v[100:103], v[152:155]
    ds_read_b64_tr_b16 v[84:85], v235 offset:16384
    ds_read_b64_tr_b16 v[86:87], v235 offset:17408
    v_mfma_f32_16x16x32_bf16 v[156:159], v[116:119], v[104:107], v[156:159]
    ds_read_b64_tr_b16 v[88:89], v236 offset:16384
    ds_read_b64_tr_b16 v[90:91], v236 offset:17408
    v_mfma_f32_16x16x32_bf16 v[160:163], v[120:123], v[100:103], v[160:163]
    ds_read_b64_tr_b16 v[92:93], v237 offset:16384
    ds_read_b64_tr_b16 v[94:95], v237 offset:17408
    v_mfma_f32_16x16x32_bf16 v[164:167], v[120:123], v[104:107], v[164:167]
    s_movk_i32 s57, 384
    s_add_u32 m0, s54, 0
    s_nop 0
    buffer_load_dwordx4 v10, s[20:23], s57 offen lds
    s_add_u32 m0, s54, 1024
    s_nop 0
    buffer_load_dwordx4 v11, s[20:23], s57 offen lds
    v_mfma_f32_16x16x32_bf16 v[168:171], v[124:127], v[100:103], v[168:171]
    s_mov_b32 s58, 589824
    s_add_u32 m0, s54, 49152
    s_nop 0
    buffer_load_dwordx4 v12, s[24:27], s58 offen lds
    s_add_u32 m0, s54, 50176
    s_nop 0
    buffer_load_dwordx4 v13, s[24:27], s58 offen lds
    v_mfma_f32_16x16x32_bf16 v[172:175], v[124:127], v[104:107], v[172:175]
    s_mov_b32 s59, 688128
    s_add_u32 m0, s54, 98304
    s_nop 0
    buffer_load_dwordx4 v14, s[28:31], s59 offen lds
    s_add_u32 m0, s54, 99328
    s_nop 0
    buffer_load_dwordx4 v15, s[28:31], s59 offen lds
    v_mfma_f32_16x16x32_bf16 v[176:179], v[128:131], v[100:103], v[176:179]
    v_mfma_f32_16x16x32_bf16 v[180:183], v[128:131], v[104:107], v[180:183]
    v_mfma_f32_16x16x32_bf16 v[192:195], v[228:231], v[100:103], v[192:195]
    v_mfma_f32_16x16x32_bf16 v[196:199], v[100:103], v[100:103], v[196:199]
    s_waitcnt lgkmcnt(0)
    v_mfma_f32_16x16x32_bf16 v[136:139], v[72:75], v[64:67], v[136:139]
    ds_read_b128 v[100:103], v17 offset:16384
    ds_read_b128 v[104:107], v19 offset:16384
    v_mfma_f32_16x16x32_bf16 v[140:143], v[72:75], v[68:71], v[140:143]
    ds_read_b64_tr_b16 v[108:109], v232 offset:24576
    ds_read_b64_tr_b16 v[110:111], v232 offset:25600
    v_mfma_f32_16x16x32_bf16 v[144:147], v[76:79], v[64:67], v[144:147]
    ds_read_b64_tr_b16 v[112:113], v233 offset:24576
    ds_read_b64_tr_b16 v[114:115], v233 offset:25600
    v_mfma_f32_16x16x32_bf16 v[148:151], v[76:79], v[68:71], v[148:151]
    ds_read_b64_tr_b16 v[116:117], v234 offset:24576
    ds_read_b64_tr_b16 v[118:119], v234 offset:25600
    v_mfma_f32_16x16x32_bf16 v[152:155], v[80:83], v[64:67], v[152:155]
    ds_read_b64_tr_b16 v[120:121], v235 offset:24576
    ds_read_b64_tr_b16 v[122:123], v235 offset:25600
    v_mfma_f32_16x16x32_bf16 v[156:159], v[80:83], v[68:71], v[156:159]
    ds_read_b64_tr_b16 v[124:125], v236 offset:24576
    ds_read_b64_tr_b16 v[126:127], v236 offset:25600
    v_mfma_f32_16x16x32_bf16 v[160:163], v[84:87], v[64:67], v[160:163]
    ds_read_b64_tr_b16 v[128:129], v237 offset:24576
    ds_read_b64_tr_b16 v[130:131], v237 offset:25600
    v_mfma_f32_16x16x32_bf16 v[164:167], v[84:87], v[68:71], v[164:167]
    s_mul_i32 s63, s62, 5
    buffer_load_dword v255, v254, s[76:79], s63 offen
    v_mfma_f32_16x16x32_bf16 v[168:171], v[88:91], v[64:67], v[168:171]
    v_mfma_f32_16x16x32_bf16 v[172:175], v[88:91], v[68:71], v[172:175]
    v_mfma_f32_16x16x32_bf16 v[176:179], v[92:95], v[64:67], v[176:179]
    v_mfma_f32_16x16x32_bf16 v[180:183], v[92:95], v[68:71], v[180:183]
    v_mfma_f32_16x16x32_bf16 v[192:195], v[228:231], v[64:67], v[192:195]
    v_mfma_f32_16x16x32_bf16 v[196:199], v[64:67], v[64:67], v[196:199]
    s_waitcnt vmcnt(8) lgkmcnt(0)
    s_barrier
    s_cmp_lg_u32 s47, 0
    s_cbranch_scc1 K1_CS_0_1_1
    v_mfma_f32_16x16x32_bf16 v[200:203], v[72:75], v[228:231], v[200:203]
    v_mfma_f32_16x16x32_bf16 v[204:207], v[88:91], v[228:231], v[204:207]
    v_mfma_f32_16x16x32_bf16 v[200:203], v[108:111], v[228:231], v[200:203]
    v_mfma_f32_16x16x32_bf16 v[204:207], v[124:127], v[228:231], v[204:207]
    s_branch K1_CS_0_1_e
K1_CS_0_1_1:
    s_cmp_lg_u32 s47, 1
    s_cbranch_scc1 K1_CS_0_1_2
    v_mfma_f32_16x16x32_bf16 v[200:203], v[76:79], v[228:231], v[200:203]
    v_mfma_f32_16x16x32_bf16 v[204:207], v[92:95], v[228:231], v[204:207]
    v_mfma_f32_16x16x32_bf16 v[200:203], v[112:115], v[228:231], v[200:203]
    v_mfma_f32_16x16x32_bf16 v[204:207], v[128:131], v[228:231], v[204:207]
    s_branch K1_CS_0_1_e
K1_CS_0_1_2:
    s_cmp_lg_u32 s47, 2
    s_cbranch_scc1 K1_CS_0_1_3
    v_mfma_f32_16x16x32_bf16 v[200:203], v[80:83], v[228:231], v[200:203]
    v_mfma_f32_16x16x32_bf16 v[200:203], v[116:119], v[228:231], v[200:203]
    s_branch K1_CS_0_1_e
K1_CS_0_1_3:
    v_mfma_f32_16x16x32_bf16 v[200:203], v[84:87], v[228:231], v[200:203]
    v_mfma_f32_16x16x32_bf16 v[200:203], v[120:123], v[228:231], v[200:203]
K1_CS_0_1_e:
    v_mfma_f32_16x16x32_bf16 v[136:139], v[108:111], v[100:103], v[136:139]
    ds_read_b128 v[64:67], v16 offset:32768
    ds_read_b128 v[68:71], v18 offset:32768
    v_mfma_f32_16x16x32_bf16 v[140:143], v[108:111], v[104:107], v[140:143]
    ds_read_b64_tr_b16 v[72:73], v232 offset:32768
    ds_read_b64_tr_b16 v[74:75], v232 offset:33792
    v_mfma_f32_16x16x32_bf16 v[144:147], v[112:115], v[100:103], v[144:147]
    ds_read_b64_tr_b16 v[76:77], v233 offset:32768
    ds_read_b64_tr_b16 v[78:79], v233 offset:33792
    v_mfma_f32_16x16x32_bf16 v[148:151], v[112:115], v[104:107], v[148:151]
    ds_read_b64_tr_b16 v[80:81], v234 offset:32768
    ds_read_b64_tr_b16 v[82:83], v234 offset:33792
    v_mfma_f32_16x16x32_bf16 v[152:155], v[116:119], v[100:103], v[152:155]
    ds_read_b64_tr_b16 v[84:85], v235 offset:32768
    ds_read_b64_tr_b16 v[86:87], v235 offset:33792
    v_mfma_f32_16x16x32_bf16 v[156:159], v[116:119], v[104:107], v[156:159]
    ds_read_b64_tr_b16 v[88:89], v236 offset:32768
    ds_read_b64_tr_b16 v[90:91], v236 offset:33792
    v_mfma_f32_16x16x32_bf16 v[160:163], v[120:123], v[100:103], v[160:163]
    ds_read_b64_tr_b16 v[92:93], v237 offset:32768
    ds_read_b64_tr_b16 v[94:95], v237 offset:33792
    v_mfma_f32_16x16x32_bf16 v[164:167], v[120:123], v[104:107], v[164:167]
    s_movk_i32 s57, 512
    s_add_u32 m0, s54, 16384
    s_nop 0
    buffer_load_dwordx4 v10, s[20:23], s57 offen lds
    s_add_u32 m0, s54, 17408
    s_nop 0
    buffer_load_dwordx4 v11, s[20:23], s57 offen lds
    v_mfma_f32_16x16x32_bf16 v[168:171], v[124:127], v[100:103], v[168:171]
    s_mov_b32 s58, 786432
    s_add_u32 m0, s54, 65536
    s_nop 0
    buffer_load_dwordx4 v12, s[24:27], s58 offen lds
    s_add_u32 m0, s54, 66560
    s_nop 0
    buffer_load_dwordx4 v13, s[24:27], s58 offen lds
    v_mfma_f32_16x16x32_bf16 v[172:175], v[124:127], v[104:107], v[172:175]
    s_mov_b32 s59, 917504
    s_add_u32 m0, s54, 114688
    s_nop 0
    buffer_load_dwordx4 v14, s[28:31], s59 offen lds
    s_add_u32 m0, s54, 115712
    s_nop 0
    buffer_load_dwordx4 v15, s[28:31], s59 offen lds
    v_mfma_f32_16x16x32_bf16 v[176:179], v[128:131], v[100:103], v[176:179]
    v_mfma_f32_16x16x32_bf16 v[180:183], v[128:131], v[104:107], v[180:183]
    v_mfma_f32_16x16x32_bf16 v[192:195], v[228:231], v[100:103], v[192:195]
    v_mfma_f32_16x16x32_bf16 v[196:199], v[100:103], v[100:103], v[196:199]
    s_waitcnt lgkmcnt(0)
    v_mfma_f32_16x16x32_bf16 v[136:139], v[72:75], v[64:67], v[136:139]
    ds_read_b128 v[100:103], v17 offset:32768
    ds_read_b128 v[104:107], v19 offset:32768
    v_mfma_f32_16x16x32_bf16 v[140:143], v[72:75], v[68:71], v[140:143]
    ds_read_b64_tr_b16 v[108:109], v232 offset:40960
    ds_read_b64_tr_b16 v[110:111], v232 offset:41984
    v_mfma_f32_16x16x32_bf16 v[144:147], v[76:79], v[64:67], v[144:147]
    ds_read_b64_tr_b16 v[112:113], v233 offset:40960
    ds_read_b64_tr_b16 v[114:115], v233 offset:41984
    v_mfma_f32_16x16x32_bf16 v[148:151], v[76:79], v[68:71], v[148:151]
    ds_read_b64_tr_b16 v[116:117], v234 offset:40960
    ds_read_b64_tr_b16 v[118:119], v234 offset:41984
    v_mfma_f32_16x16x32_bf16 v[152:155], v[80:83], v[64:67], v[152:155]
    ds_read_b64_tr_b16 v[120:121], v235 offset:40960
    ds_read_b64_tr_b16 v[122:123], v235 offset:41984
    v_mfma_f32_16x16x32_bf16 v[156:159], v[80:83], v[68:71], v[156:159]
    ds_read_b64_tr_b16 v[124:125], v236 offset:40960
    ds_read_b64_tr_b16 v[126:127], v236 offset:41984
    v_mfma_f32_16x16x32_bf16 v[160:163], v[84:87], v[64:67], v[160:163]
    ds_read_b64_tr_b16 v[128:129], v237 offset:40960
    ds_read_b64_tr_b16 v[130:131], v237 offset:41984
    v_mfma_f32_16x16x32_bf16 v[164:167], v[84:87], v[68:71], v[164:167]
    s_mul_i32 s63, s62, 6
    buffer_load_dword v255, v254, s[76:79], s63 offen
    v_mfma_f32_16x16x32_bf16 v[168:171], v[88:91], v[64:67], v[168:171]
    v_mfma_f32_16x16x32_bf16 v[172:175], v[88:91], v[68:71], v[172:175]
    v_mfma_f32_16x16x32_bf16 v[176:179], v[92:95], v[64:67], v[176:179]
    v_mfma_f32_16x16x32_bf16 v[180:183], v[92:95], v[68:71], v[180:183]
    v_mfma_f32_16x16x32_bf16 v[192:195], v[228:231], v[64:67], v[192:195]
    v_mfma_f32_16x16x32_bf16 v[196:199], v[64:67], v[64:67], v[196:199]
    s_waitcnt vmcnt(8) lgkmcnt(0)
    s_barrier
    s_cmp_lg_u32 s47, 0
    s_cbranch_scc1 K1_CS_0_2_1
    v_mfma_f32_16x16x32_bf16 v[200:203], v[72:75], v[228:231], v[200:203]
    v_mfma_f32_16x16x32_bf16 v[204:207], v[88:91], v[228:231], v[204:207]
    v_mfma_f32_16x16x32_bf16 v[200:203], v[108:111], v[228:231], v[200:203]
    v_mfma_f32_16x16x32_bf16 v[204:207], v[124:127], v[228:231], v[204:207]
    s_branch K1_CS_0_2_e
K1_CS_0_2_1:
    s_cmp_lg_u32 s47, 1
    s_cbranch_scc1 K1_CS_0_2_2
    v_mfma_f32_16x16x32_bf16 v[200:203], v[76:79], v[228:231], v[200:203]
    v_mfma_f32_16x16x32_bf16 v[204:207], v[92:95], v[228:231], v[204:207]
    v_mfma_f32_16x16x32_bf16 v[200:203], v[112:115], v[228:231], v[200:203]
    v_mfma_f32_16x16x32_bf16 v[204:207], v[128:131], v[228:231], v[204:207]
    s_branch K1_CS_0_2_e
K1_CS_0_2_2:
    s_cmp_lg_u32 s47, 2
    s_cbranch_scc1 K1_CS_0_2_3
    v_mfma_f32_16x16x32_bf16 v[200:203], v[80:83], v[228:231], v[200:203]
    v_mfma_f32_16x16x32_bf16 v[200:203], v[116:119], v[228:231], v[200:203]
    s_branch K1_CS_0_2_e
K1_CS_0_2_3:
    v_mfma_f32_16x16x32_bf16 v[200:203], v[84:87], v[228:231], v[200:203]
    v_mfma_f32_16x16x32_bf16 v[200:203], v[120:123], v[228:231], v[200:203]
K1_CS_0_2_e:
    v_mfma_f32_16x16x32_bf16 v[136:139], v[108:111], v[100:103], v[136:139]
    ds_read_b128 v[64:67], v16 offset:0
    ds_read_b128 v[68:71], v18 offset:0
    v_mfma_f32_16x16x32_bf16 v[140:143], v[108:111], v[104:107], v[140:143]
    ds_read_b64_tr_b16 v[72:73], v232 offset:0
    ds_read_b64_tr_b16 v[74:75], v232 offset:1024
    v_mfma_f32_16x16x32_bf16 v[144:147], v[112:115], v[100:103], v[144:147]
    ds_read_b64_tr_b16 v[76:77], v233 offset:0
    ds_read_b64_tr_b16 v[78:79], v233 offset:1024
    v_mfma_f32_16x16x32_bf16 v[148:151], v[112:115], v[104:107], v[148:151]
    ds_read_b64_tr_b16 v[80:81], v234 offset:0
    ds_read_b64_tr_b16 v[82:83], v234 offset:1024
    v_mfma_f32_16x16x32_bf16 v[152:155], v[116:119], v[100:103], v[152:155]
    ds_read_b64_tr_b16 v[84:85], v235 offset:0
    ds_read_b64_tr_b16 v[86:87], v235 offset:1024
    v_mfma_f32_16x16x32_bf16 v[156:159], v[116:119], v[104:107], v[156:159]
    ds_read_b64_tr_b16 v[88:89], v236 offset:0
    ds_read_b64_tr_b16 v[90:91], v236 offset:1024
    v_mfma_f32_16x16x32_bf16 v[160:163], v[120:123], v[100:103], v[160:163]
    ds_read_b64_tr_b16 v[92:93], v237 offset:0
    ds_read_b64_tr_b16 v[94:95], v237 offset:1024
    v_mfma_f32_16x16x32_bf16 v[164:167], v[120:123], v[104:107], v[164:167]
    s_movk_i32 s57, 640
    s_add_u32 m0, s54, 32768
    s_nop 0
    buffer_load_dwordx4 v10, s[20:23], s57 offen lds
    s_add_u32 m0, s54, 33792
    s_nop 0
    buffer_load_dwordx4 v11, s[20:23], s57 offen lds
    v_mfma_f32_16x16x32_bf16 v[168:171], v[124:127], v[100:103], v[168:171]
    s_mov_b32 s58, 983040
    s_add_u32 m0, s54, 81920
    s_nop 0
    buffer_load_dwordx4 v12, s[24:27], s58 offen lds
    s_add_u32 m0, s54, 82944
    s_nop 0
    buffer_load_dwordx4 v13, s[24:27], s58 offen lds
    v_mfma_f32_16x16x32_bf16 v[172:175], v[124:127], v[104:107], v[172:175]
    s_mov_b32 s59, 1146880
    s_add_u32 m0, s54, 131072
    s_nop 0
    buffer_load_dwordx4 v14, s[28:31], s59 offen lds
    s_add_u32 m0, s54, 132096
    s_nop 0
    buffer_load_dwordx4 v15, s[28:31], s59 offen lds
    v_mfma_f32_16x16x32_bf16 v[176:179], v[128:131], v[100:103], v[176:179]
    v_mfma_f32_16x16x32_bf16 v[180:183], v[128:131], v[104:107], v[180:183]
    v_mfma_f32_16x16x32_bf16 v[192:195], v[228:231], v[100:103], v[192:195]
    v_mfma_f32_16x16x32_bf16 v[196:199], v[100:103], v[100:103], v[196:199]
    s_waitcnt lgkmcnt(0)
    v_mfma_f32_16x16x32_bf16 v[136:139], v[72:75], v[64:67], v[136:139]
    ds_read_b128 v[100:103], v17 offset:0
    ds_read_b128 v[104:107], v19 offset:0
    v_mfma_f32_16x16x32_bf16 v[140:143], v[72:75], v[68:71], v[140:143]
    ds_read_b64_tr_b16 v[108:109], v232 offset:8192
    ds_read_b64_tr_b16 v[110:111], v232 offset:9216
    v_mfma_f32_16x16x32_bf16 v[144:147], v[76:79], v[64:67], v[144:147]
    ds_read_b64_tr_b16 v[112:113], v233 offset:8192
    ds_read_b64_tr_b16 v[114:115], v233 offset:9216
    v_mfma_f32_16x16x32_bf16 v[148:151], v[76:79], v[68:71], v[148:151]
    ds_read_b64_tr_b16 v[116:117], v234 offset:8192
    ds_read_b64_tr_b16 v[118:119], v234 offset:9216
    v_mfma_f32_16x16x32_bf16 v[152:155], v[80:83], v[64:67], v[152:155]
    ds_read_b64_tr_b16 v[120:121], v235 offset:8192
    ds_read_b64_tr_b16 v[122:123], v235 offset:9216
    v_mfma_f32_16x16x32_bf16 v[156:159], v[80:83], v[68:71], v[156:159]
    ds_read_b64_tr_b16 v[124:125], v236 offset:8192
    ds_read_b64_tr_b16 v[126:127], v236 offset:9216
    v_mfma_f32_16x16x32_bf16 v[160:163], v[84:87], v[64:67], v[160:163]
    ds_read_b64_tr_b16 v[128:129], v237 offset:8192
    ds_read_b64_tr_b16 v[130:131], v237 offset:9216
    v_mfma_f32_16x16x32_bf16 v[164:167], v[84:87], v[68:71], v[164:167]
    s_mul_i32 s63, s62, 7
    buffer_load_dword v255, v254, s[76:79], s63 offen
    v_mfma_f32_16x16x32_bf16 v[168:171], v[88:91], v[64:67], v[168:171]
    v_mfma_f32_16x16x32_bf16 v[172:175], v[88:91], v[68:71], v[172:175]
    v_mfma_f32_16x16x32_bf16 v[176:179], v[92:95], v[64:67], v[176:179]
    v_mfma_f32_16x16x32_bf16 v[180:183], v[92:95], v[68:71], v[180:183]
    v_mfma_f32_16x16x32_bf16 v[192:195], v[228:231], v[64:67], v[192:195]
    v_mfma_f32_16x16x32_bf16 v[196:199], v[64:67], v[64:67], v[196:199]
    s_waitcnt vmcnt(8) lgkmcnt(0)
    s_barrier
    s_cmp_lg_u32 s47, 0
    s_cbranch_scc1 K1_CS_0_3_1
    v_mfma_f32_16x16x32_bf16 v[200:203], v[72:75], v[228:231], v[200:203]
    v_mfma_f32_16x16x32_bf16 v[204:207], v[88:91], v[228:231], v[204:207]
    v_mfma_f32_16x16x32_bf16 v[200:203], v[108:111], v[228:231], v[200:203]
    v_mfma_f32_16x16x32_bf16 v[204:207], v[124:127], v[228:231], v[204:207]
    s_branch K1_CS_0_3_e
K1_CS_0_3_1:
    s_cmp_lg_u32 s47, 1
    s_cbranch_scc1 K1_CS_0_3_2
    v_mfma_f32_16x16x32_bf16 v[200:203], v[76:79], v[228:231], v[200:203]
    v_mfma_f32_16x16x32_bf16 v[204:207], v[92:95], v[228:231], v[204:207]
    v_mfma_f32_16x16x32_bf16 v[200:203], v[112:115], v[228:231], v[200:203]
    v_mfma_f32_16x16x32_bf16 v[204:207], v[128:131], v[228:231], v[204:207]
    s_branch K1_CS_0_3_e
K1_CS_0_3_2:
    s_cmp_lg_u32 s47, 2
    s_cbranch_scc1 K1_CS_0_3_3
    v_mfma_f32_16x16x32_bf16 v[200:203], v[80:83], v[228:231], v[200:203]
    v_mfma_f32_16x16x32_bf16 v[200:203], v[116:119], v[228:231], v[200:203]
    s_branch K1_CS_0_3_e
K1_CS_0_3_3:
    v_mfma_f32_16x16x32_bf16 v[200:203], v[84:87], v[228:231], v[200:203]
    v_mfma_f32_16x16x32_bf16 v[200:203], v[120:123], v[228:231], v[200:203]
K1_CS_0_3_e:
    v_mfma_f32_16x16x32_bf16 v[136:139], v[108:111], v[100:103], v[136:139]
    ds_read_b128 v[64:67], v16 offset:16384
    ds_read_b128 v[68:71], v18 offset:16384
    v_mfma_f32_16x16x32_bf16 v[140:143], v[108:111], v[104:107], v[140:143]
    ds_read_b64_tr_b16 v[72:73], v232 offset:16384
    ds_read_b64_tr_b16 v[74:75], v232 offset:17408
    v_mfma_f32_16x16x32_bf16 v[144:147], v[112:115], v[100:103], v[144:147]
    ds_read_b64_tr_b16 v[76:77], v233 offset:16384
    ds_read_b64_tr_b16 v[78:79], v233 offset:17408
    v_mfma_f32_16x16x32_bf16 v[148:151], v[112:115], v[104:107], v[148:151]
    ds_read_b64_tr_b16 v[80:81], v234 offset:16384
    ds_read_b64_tr_b16 v[82:83], v234 offset:17408
    v_mfma_f32_16x16x32_bf16 v[152:155], v[116:119], v[100:103], v[152:155]
    ds_read_b64_tr_b16 v[84:85], v235 offset:16384
    ds_read_b64_tr_b16 v[86:87], v235 offset:17408
    v_mfma_f32_16x16x32_bf16 v[156:159], v[116:119], v[104:107], v[156:159]
    ds_read_b64_tr_b16 v[88:89], v236 offset:16384
    ds_read_b64_tr_b16 v[90:91], v236 offset:17408
    v_mfma_f32_16x16x32_bf16 v[160:163], v[120:123], v[100:103], v[160:163]
    ds_read_b64_tr_b16 v[92:93], v237 offset:16384
    ds_read_b64_tr_b16 v[94:95], v237 offset:17408
    v_mfma_f32_16x16x32_bf16 v[164:167], v[120:123], v[104:107], v[164:167]
    s_movk_i32 s57, 768
    s_add_u32 m0, s54, 0
    s_nop 0
    buffer_load_dwordx4 v10, s[20:23], s57 offen lds
    s_add_u32 m0, s54, 1024
    s_nop 0
    buffer_load_dwordx4 v11, s[20:23], s57 offen lds
    v_mfma_f32_16x16x32_bf16 v[168:171], v[124:127], v[100:103], v[168:171]
    s_mov_b32 s58, 1179648
    s_add_u32 m0, s54, 49152
    s_nop 0
    buffer_load_dwordx4 v12, s[24:27], s58 offen lds
    s_add_u32 m0, s54, 50176
    s_nop 0
    buffer_load_dwordx4 v13, s[24:27], s58 offen lds
    v_mfma_f32_16x16x32_bf16 v[172:175], v[124:127], v[104:107], v[172:175]
    s_mov_b32 s59, 1376256
    s_add_u32 m0, s54, 98304
    s_nop 0
    buffer_load_dwordx4 v14, s[28:31], s59 offen lds
    s_add_u32 m0, s54, 99328
    s_nop 0
    buffer_load_dwordx4 v15, s[28:31], s59 offen lds
    v_mfma_f32_16x16x32_bf16 v[176:179], v[128:131], v[100:103], v[176:179]
    v_mfma_f32_16x16x32_bf16 v[180:183], v[128:131], v[104:107], v[180:183]
    v_mfma_f32_16x16x32_bf16 v[192:195], v[228:231], v[100:103], v[192:195]
    v_mfma_f32_16x16x32_bf16 v[196:199], v[100:103], v[100:103], v[196:199]
    s_waitcnt lgkmcnt(0)
    v_mfma_f32_16x16x32_bf16 v[136:139], v[72:75], v[64:67], v[136:139]
    ds_read_b128 v[100:103], v17 offset:16384
    ds_read_b128 v[104:107], v19 offset:16384
    v_mfma_f32_16x16x32_bf16 v[140:143], v[72:75], v[68:71], v[140:143]
    ds_read_b64_tr_b16 v[108:109], v232 offset:24576
    ds_read_b64_tr_b16 v[110:111], v232 offset:25600
    v_mfma_f32_16x16x32_bf16 v[144:147], v[76:79], v[64:67], v[144:147]
    ds_read_b64_tr_b16 v[112:113], v233 offset:24576
    ds_read_b64_tr_b16 v[114:115], v233 offset:25600
    v_mfma_f32_16x16x32_bf16 v[148:151], v[76:79], v[68:71], v[148:151]
    ds_read_b64_tr_b16 v[116:117], v234 offset:24576
    ds_read_b64_tr_b16 v[118:119], v234 offset:25600
    v_mfma_f32_16x16x32_bf16 v[152:155], v[80:83], v[64:67], v[152:155]
    ds_read_b64_tr_b16 v[120:121], v235 offset:24576
    ds_read_b64_tr_b16 v[122:123], v235 offset:25600
    v_mfma_f32_16x16x32_bf16 v[156:159], v[80:83], v[68:71], v[156:159]
    ds_read_b64_tr_b16 v[124:125], v236 offset:24576
    ds_read_b64_tr_b16 v[126:127], v236 offset:25600
    v_mfma_f32_16x16x32_bf16 v[160:163], v[84:87], v[64:67], v[160:163]
    ds_read_b64_tr_b16 v[128:129], v237 offset:24576
    ds_read_b64_tr_b16 v[130:131], v237 offset:25600
    v_mfma_f32_16x16x32_bf16 v[164:167], v[84:87], v[68:71], v[164:167]
    v_mfma_f32_16x16x32_bf16 v[168:171], v[88:91], v[64:67], v[168:171]
    v_mfma_f32_16x16x32_bf16 v[172:175], v[88:91], v[68:71], v[172:175]
    v_mfma_f32_16x16x32_bf16 v[176:179], v[92:95], v[64:67], v[176:179]
    v_mfma_f32_16x16x32_bf16 v[180:183], v[92:95], v[68:71], v[180:183]
    v_mfma_f32_16x16x32_bf16 v[192:195], v[228:231], v[64:67], v[192:195]
    v_mfma_f32_16x16x32_bf16 v[196:199], v[64:67], v[64:67], v[196:199]
    s_waitcnt vmcnt(7) lgkmcnt(0)
    s_barrier
    s_cmp_lg_u32 s47, 0
    s_cbranch_scc1 K1_CS_0_4_1
    v_mfma_f32_16x16x32_bf16 v[200:203], v[72:75], v[228:231], v[200:203]
    v_mfma_f32_16x16x32_bf16 v[204:207], v[88:91], v[228:231], v[204:207]
    v_mfma_f32_16x16x32_bf16 v[200:203], v[108:111], v[228:231], v[200:203]
    v_mfma_f32_16x16x32_bf16 v[204:207], v[124:127], v[228:231], v[204:207]
    s_branch K1_CS_0_4_e
K1_CS_0_4_1:
    s_cmp_lg_u32 s47, 1
    s_cbranch_scc1 K1_CS_0_4_2
    v_mfma_f32_16x16x32_bf16 v[200:203], v[76:79], v[228:231], v[200:203]
    v_mfma_f32_16x16x32_bf16 v[204:207], v[92:95], v[228:231], v[204:207]
    v_mfma_f32_16x16x32_bf16 v[200:203], v[112:115], v[228:231], v[200:203]
    v_mfma_f32_16x16x32_bf16 v[204:207], v[128:131], v[228:231], v[204:207]
    s_branch K1_CS_0_4_e
K1_CS_0_4_2:
    s_cmp_lg_u32 s47, 2
    s_cbranch_scc1 K1_CS_0_4_3
    v_mfma_f32_16x16x32_bf16 v[200:203], v[80:83], v[228:231], v[200:203]
    v_mfma_f32_16x16x32_bf16 v[200:203], v[116:119], v[228:231], v[200:203]
    s_branch K1_CS_0_4_e
K1_CS_0_4_3:
    v_mfma_f32_16x16x32_bf16 v[200:203], v[84:87], v[228:231], v[200:203]
    v_mfma_f32_16x16x32_bf16 v[200:203], v[120:123], v[228:231], v[200:203]
K1_CS_0_4_e:
    v_mfma_f32_16x16x32_bf16 v[136:139], v[108:111], v[100:103], v[136:139]
    ds_read_b128 v[64:67], v16 offset:32768
    ds_read_b128 v[68:71], v18 offset:32768
    v_mfma_f32_16x16x32_bf16 v[140:143], v[108:111], v[104:107], v[140:143]
    ds_read_b64_tr_b16 v[72:73], v232 offset:32768
    ds_read_b64_tr_b16 v[74:75], v232 offset:33792
    v_mfma_f32_16x16x32_bf16 v[144:147], v[112:115], v[100:103], v[144:147]
    ds_read_b64_tr_b16 v[76:77], v233 offset:32768
    ds_read_b64_tr_b16 v[78:79], v233 offset:33792
    v_mfma_f32_16x16x32_bf16 v[148:151], v[112:115], v[104:107], v[148:151]
    ds_read_b64_tr_b16 v[80:81], v234 offset:32768
    ds_read_b64_tr_b16 v[82:83], v234 offset:33792
    v_mfma_f32_16x16x32_bf16 v[152:155], v[116:119], v[100:103], v[152:155]
    ds_read_b64_tr_b16 v[84:85], v235 offset:32768
    ds_read_b64_tr_b16 v[86:87], v235 offset:33792
    v_mfma_f32_16x16x32_bf16 v[156:159], v[116:119], v[104:107], v[156:159]
    ds_read_b64_tr_b16 v[88:89], v236 offset:32768
    ds_read_b64_tr_b16 v[90:91], v236 offset:33792
    v_mfma_f32_16x16x32_bf16 v[160:163], v[120:123], v[100:103], v[160:163]
    ds_read_b64_tr_b16 v[92:93], v237 offset:32768
    ds_read_b64_tr_b16 v[94:95], v237 offset:33792
    v_mfma_f32_16x16x32_bf16 v[164:167], v[120:123], v[104:107], v[164:167]
    s_movk_i32 s57, 896
    s_add_u32 m0, s54, 16384
    s_nop 0
    buffer_load_dwordx4 v10, s[20:23], s57 offen lds
    s_add_u32 m0, s54, 17408
    s_nop 0
    buffer_load_dwordx4 v11, s[20:23], s57 offen lds
    v_mfma_f32_16x16x32_bf16 v[168:171], v[124:127], v[100:103], v[168:171]
    s_mov_b32 s58, 1376256
    s_add_u32 m0, s54, 65536
    s_nop 0
    buffer_load_dwordx4 v12, s[24:27], s58 offen lds
    s_add_u32 m0, s54, 66560
    s_nop 0
    buffer_load_dwordx4 v13, s[24:27], s58 offen lds
    v_mfma_f32_16x16x32_bf16 v[172:175], v[124:127], v[104:107], v[172:175]
    s_mov_b32 s59, 1605632
    s_add_u32 m0, s54, 114688
    s_nop 0
    buffer_load_dwordx4 v14, s[28:31], s59 offen lds
    s_add_u32 m0, s54, 115712
    s_nop 0
    buffer_load_dwordx4 v15, s[28:31], s59 offen lds
    v_mfma_f32_16x16x32_bf16 v[176:179], v[128:131], v[100:103], v[176:179]
    v_mfma_f32_16x16x32_bf16 v[180:183], v[128:131], v[104:107], v[180:183]
    v_mfma_f32_16x16x32_bf16 v[192:195], v[228:231], v[100:103], v[192:195]
    v_mfma_f32_16x16x32_bf16 v[196:199], v[100:103], v[100:103], v[196:199]
    s_waitcnt lgkmcnt(0)
    v_mfma_f32_16x16x32_bf16 v[136:139], v[72:75], v[64:67], v[136:139]
    ds_read_b128 v[100:103], v17 offset:32768
    ds_read_b128 v[104:107], v19 offset:32768
    v_mfma_f32_16x16x32_bf16 v[140:143], v[72:75], v[68:71], v[140:143]
    ds_read_b64_tr_b16 v[108:109], v232 offset:40960
    ds_read_b64_tr_b16 v[110:111], v232 offset:41984
    v_mfma_f32_16x16x32_bf16 v[144:147], v[76:79], v[64:67], v[144:147]
    ds_read_b64_tr_b16 v[112:113], v233 offset:40960
    ds_read_b64_tr_b16 v[114:115], v233 offset:41984
    v_mfma_f32_16x16x32_bf16 v[148:151], v[76:79], v[68:71], v[148:151]
    ds_read_b64_tr_b16 v[116:117], v234 offset:40960
    ds_read_b64_tr_b16 v[118:119], v234 offset:41984
    v_mfma_f32_16x16x32_bf16 v[152:155], v[80:83], v[64:67], v[152:155]
    ds_read_b64_tr_b16 v[120:121], v235 offset:40960
    ds_read_b64_tr_b16 v[122:123], v235 offset:41984
    v_mfma_f32_16x16x32_bf16 v[156:159], v[80:83], v[68:71], v[156:159]
    ds_read_b64_tr_b16 v[124:125], v236 offset:40960
    ds_read_b64_tr_b16 v[126:127], v236 offset:41984
    v_mfma_f32_16x16x32_bf16 v[160:163], v[84:87], v[64:67], v[160:163]
    ds_read_b64_tr_b16 v[128:129], v237 offset:40960
    ds_read_b64_tr_b16 v[130:131], v237 offset:41984
    v_mfma_f32_16x16x32_bf16 v[164:167], v[84:87], v[68:71], v[164:167]
    v_mfma_f32_16x16x32_bf16 v[168:171], v[88:91], v[64:67], v[168:171]
    v_mfma_f32_16x16x32_bf16 v[172:175], v[88:91], v[68:71], v[172:175]
    v_mfma_f32_16x16x32_bf16 v[176:179], v[92:95], v[64:67], v[176:179]
    v_mfma_f32_16x16x32_bf16 v[180:183], v[92:95], v[68:71], v[180:183]
    v_mfma_f32_16x16x32_bf16 v[192:195], v[228:231], v[64:67], v[192:195]
    v_mfma_f32_16x16x32_bf16 v[196:199], v[64:67], v[64:67], v[196:199]
    s_waitcnt vmcnt(6) lgkmcnt(0)
    s_barrier
    s_cmp_lg_u32 s47, 0
    s_cbranch_scc1 K1_CS_0_5_1
    v_mfma_f32_16x16x32_bf16 v[200:203], v[72:75], v[228:231], v[200:203]
    v_mfma_f32_16x16x32_bf16 v[204:207], v[88:91], v[228:231], v[204:207]
    v_mfma_f32_16x16x32_bf16 v[200:203], v[108:111], v[228:231], v[200:203]
    v_mfma_f32_16x16x32_bf16 v[204:207], v[124:127], v[228:231], v[204:207]
    s_branch K1_CS_0_5_e
K1_CS_0_5_1:
    s_cmp_lg_u32 s47, 1
    s_cbranch_scc1 K1_CS_0_5_2
    v_mfma_f32_16x16x32_bf16 v[200:203], v[76:79], v[228:231], v[200:203]
    v_mfma_f32_16x16x32_bf16 v[204:207], v[92:95], v[228:231], v[204:207]
    v_mfma_f32_16x16x32_bf16 v[200:203], v[112:115], v[228:231], v[200:203]
    v_mfma_f32_16x16x32_bf16 v[204:207], v[128:131], v[228:231], v[204:207]
    s_branch K1_CS_0_5_e
K1_CS_0_5_2:
    s_cmp_lg_u32 s47, 2
    s_cbranch_scc1 K1_CS_0_5_3
    v_mfma_f32_16x16x32_bf16 v[200:203], v[80:83], v[228:231], v[200:203]
    v_mfma_f32_16x16x32_bf16 v[200:203], v[116:119], v[228:231], v[200:203]
    s_branch K1_CS_0_5_e
K1_CS_0_5_3:
    v_mfma_f32_16x16x32_bf16 v[200:203], v[84:87], v[228:231], v[200:203]
    v_mfma_f32_16x16x32_bf16 v[200:203], v[120:123], v[228:231], v[200:203]
K1_CS_0_5_e:
    v_mfma_f32_16x16x32_bf16 v[136:139], v[108:111], v[100:103], v[136:139]
    ds_read_b128 v[64:67], v16 offset:0
    ds_read_b128 v[68:71], v18 offset:0
    v_mfma_f32_16x16x32_bf16 v[140:143], v[108:111], v[104:107], v[140:143]
    ds_read_b64_tr_b16 v[72:73], v232 offset:0
    ds_read_b64_tr_b16 v[74:75], v232 offset:1024
    v_mfma_f32_16x16x32_bf16 v[144:147], v[112:115], v[100:103], v[144:147]
    ds_read_b64_tr_b16 v[76:77], v233 offset:0
    ds_read_b64_tr_b16 v[78:79], v233 offset:1024
    v_mfma_f32_16x16x32_bf16 v[148:151], v[112:115], v[104:107], v[148:151]
    ds_read_b64_tr_b16 v[80:81], v234 offset:0
    ds_read_b64_tr_b16 v[82:83], v234 offset:1024
    v_mfma_f32_16x16x32_bf16 v[152:155], v[116:119], v[100:103], v[152:155]
    ds_read_b64_tr_b16 v[84:85], v235 offset:0
    ds_read_b64_tr_b16 v[86:87], v235 offset:1024
    v_mfma_f32_16x16x32_bf16 v[156:159], v[116:119], v[104:107], v[156:159]
    ds_read_b64_tr_b16 v[88:89], v236 offset:0
    ds_read_b64_tr_b16 v[90:91], v236 offset:1024
    v_mfma_f32_16x16x32_bf16 v[160:163], v[120:123], v[100:103], v[160:163]
    ds_read_b64_tr_b16 v[92:93], v237 offset:0
    ds_read_b64_tr_b16 v[94:95], v237 offset:1024
    v_mfma_f32_16x16x32_bf16 v[164:167], v[120:123], v[104:107], v[164:167]
    v_mfma_f32_16x16x32_bf16 v[168:171], v[124:127], v[100:103], v[168:171]
    v_mfma_f32_16x16x32_bf16 v[172:175], v[124:127], v[104:107], v[172:175]
    v_mfma_f32_16x16x32_bf16 v[176:179], v[128:131], v[100:103], v[176:179]
    v_mfma_f32_16x16x32_bf16 v[180:183], v[128:131], v[104:107], v[180:183]
    v_mfma_f32_16x16x32_bf16 v[192:195], v[228:231], v[100:103], v[192:195]
    v_mfma_f32_16x16x32_bf16 v[196:199], v[100:103], v[100:103], v[196:199]
    s_waitcnt lgkmcnt(0)
    v_mfma_f32_16x16x32_bf16 v[136:139], v[72:75], v[64:67], v[136:139]
    ds_read_b128 v[100:103], v17 offset:0
    ds_read_b128 v[104:107], v19 offset:0
    v_mfma_f32_16x16x32_bf16 v[140:143], v[72:75], v[68:71], v[140:143]
    ds_read_b64_tr_b16 v[108:109], v232 offset:8192
    ds_read_b64_tr_b16 v[110:111], v232 offset:9216
    v_mfma_f32_16x16x32_bf16 v[144:147], v[76:79], v[64:67], v[144:147]
    ds_read_b64_tr_b16 v[112:113], v233 offset:8192
    ds_read_b64_tr_b16 v[114:115], v233 offset:9216
    v_mfma_f32_16x16x32_bf16 v[148:151], v[76:79], v[68:71], v[148:151]
    ds_read_b64_tr_b16 v[116:117], v234 offset:8192
    ds_read_b64_tr_b16 v[118:119], v234 offset:9216
    v_mfma_f32_16x16x32_bf16 v[152:155], v[80:83], v[64:67], v[152:155]
    ds_read_b64_tr_b16 v[120:121], v235 offset:8192
    ds_read_b64_tr_b16 v[122:123], v235 offset:9216
    v_mfma_f32_16x16x32_bf16 v[156:159], v[80:83], v[68:71], v[156:159]
    ds_read_b64_tr_b16 v[124:125], v236 offset:8192
    ds_read_b64_tr_b16 v[126:127], v236 offset:9216
    v_mfma_f32_16x16x32_bf16 v[160:163], v[84:87], v[64:67], v[160:163]
    ds_read_b64_tr_b16 v[128:129], v237 offset:8192
    ds_read_b64_tr_b16 v[130:131], v237 offset:9216
    v_mfma_f32_16x16x32_bf16 v[164:167], v[84:87], v[68:71], v[164:167]
    s_lshr_b32 s51, s2, 3
    v_lshlrev_b32 v4, 7, v1
    s_mul_i32 s40, s51, 57344
    s_lshl_b32 s41, s46, 13
    s_add_u32 s40, s40, s41
    s_lshl_b32 s41, s51, 14
    s_cmp_eq_u32 s46, 7
    s_cbranch_scc1 K1_PW_0_o
    buffer_load_dword v255, v4, s[68:71], s40 offen
    s_branch K1_PW_0_e
K1_PW_0_o:
    buffer_load_dword v255, v4, s[72:75], s41 offen
K1_PW_0_e:

    s_add_u32 s41, s41, 8192
    buffer_load_dword v255, v4, s[72:75], s41 offen

    v_mfma_f32_16x16x32_bf16 v[168:171], v[88:91], v[64:67], v[168:171]
    v_mfma_f32_16x16x32_bf16 v[172:175], v[88:91], v[68:71], v[172:175]
    v_mfma_f32_16x16x32_bf16 v[176:179], v[92:95], v[64:67], v[176:179]
    v_mfma_f32_16x16x32_bf16 v[180:183], v[92:95], v[68:71], v[180:183]
    v_mfma_f32_16x16x32_bf16 v[192:195], v[228:231], v[64:67], v[192:195]
    v_mfma_f32_16x16x32_bf16 v[196:199], v[64:67], v[64:67], v[196:199]
    s_waitcnt vmcnt(2) lgkmcnt(0)
    s_barrier
    s_cmp_lg_u32 s47, 0
    s_cbranch_scc1 K1_CS_0_6_1
    v_mfma_f32_16x16x32_bf16 v[200:203], v[72:75], v[228:231], v[200:203]
    v_mfma_f32_16x16x32_bf16 v[204:207], v[88:91], v[228:231], v[204:207]
    v_mfma_f32_16x16x32_bf16 v[200:203], v[108:111], v[228:231], v[200:203]
    v_mfma_f32_16x16x32_bf16 v[204:207], v[124:127], v[228:231], v[204:207]
    s_branch K1_CS_0_6_e
K1_CS_0_6_1:
    s_cmp_lg_u32 s47, 1
    s_cbranch_scc1 K1_CS_0_6_2
    v_mfma_f32_16x16x32_bf16 v[200:203], v[76:79], v[228:231], v[200:203]
    v_mfma_f32_16x16x32_bf16 v[204:207], v[92:95], v[228:231], v[204:207]
    v_mfma_f32_16x16x32_bf16 v[200:203], v[112:115], v[228:231], v[200:203]
    v_mfma_f32_16x16x32_bf16 v[204:207], v[128:131], v[228:231], v[204:207]
    s_branch K1_CS_0_6_e
K1_CS_0_6_2:
    s_cmp_lg_u32 s47, 2
    s_cbranch_scc1 K1_CS_0_6_3
    v_mfma_f32_16x16x32_bf16 v[200:203], v[80:83], v[228:231], v[200:203]
    v_mfma_f32_16x16x32_bf16 v[200:203], v[116:119], v[228:231], v[200:203]
    s_branch K1_CS_0_6_e
K1_CS_0_6_3:
    v_mfma_f32_16x16x32_bf16 v[200:203], v[84:87], v[228:231], v[200:203]
    v_mfma_f32_16x16x32_bf16 v[200:203], v[120:123], v[228:231], v[200:203]
K1_CS_0_6_e:
    v_mfma_f32_16x16x32_bf16 v[136:139], v[108:111], v[100:103], v[136:139]
    ds_read_b128 v[64:67], v16 offset:16384
    ds_read_b128 v[68:71], v18 offset:16384
    v_mfma_f32_16x16x32_bf16 v[140:143], v[108:111], v[104:107], v[140:143]
    ds_read_b64_tr_b16 v[72:73], v232 offset:16384
    ds_read_b64_tr_b16 v[74:75], v232 offset:17408
    v_mfma_f32_16x16x32_bf16 v[144:147], v[112:115], v[100:103], v[144:147]
    ds_read_b64_tr_b16 v[76:77], v233 offset:16384
    ds_read_b64_tr_b16 v[78:79], v233 offset:17408
    v_mfma_f32_16x16x32_bf16 v[148:151], v[112:115], v[104:107], v[148:151]
    ds_read_b64_tr_b16 v[80:81], v234 offset:16384
    ds_read_b64_tr_b16 v[82:83], v234 offset:17408
    v_mfma_f32_16x16x32_bf16 v[152:155], v[116:119], v[100:103], v[152:155]
    ds_read_b64_tr_b16 v[84:85], v235 offset:16384
    ds_read_b64_tr_b16 v[86:87], v235 offset:17408
    v_mfma_f32_16x16x32_bf16 v[156:159], v[116:119], v[104:107], v[156:159]
    ds_read_b64_tr_b16 v[88:89], v236 offset:16384
    ds_read_b64_tr_b16 v[90:91], v236 offset:17408
    v_mfma_f32_16x16x32_bf16 v[160:163], v[120:123], v[100:103], v[160:163]
    ds_read_b64_tr_b16 v[92:93], v237 offset:16384
    ds_read_b64_tr_b16 v[94:95], v237 offset:17408
    v_mfma_f32_16x16x32_bf16 v[164:167], v[120:123], v[104:107], v[164:167]
    v_mfma_f32_16x16x32_bf16 v[168:171], v[124:127], v[100:103], v[168:171]
    v_mfma_f32_16x16x32_bf16 v[172:175], v[124:127], v[104:107], v[172:175]
    v_mfma_f32_16x16x32_bf16 v[176:179], v[128:131], v[100:103], v[176:179]
    v_mfma_f32_16x16x32_bf16 v[180:183], v[128:131], v[104:107], v[180:183]
    v_mfma_f32_16x16x32_bf16 v[192:195], v[228:231], v[100:103], v[192:195]
    v_mfma_f32_16x16x32_bf16 v[196:199], v[100:103], v[100:103], v[196:199]
    s_waitcnt lgkmcnt(0)
    v_mfma_f32_16x16x32_bf16 v[136:139], v[72:75], v[64:67], v[136:139]
    ds_read_b128 v[100:103], v17 offset:16384
    ds_read_b128 v[104:107], v19 offset:16384
    v_mfma_f32_16x16x32_bf16 v[140:143], v[72:75], v[68:71], v[140:143]
    ds_read_b64_tr_b16 v[108:109], v232 offset:24576
    ds_read_b64_tr_b16 v[110:111], v232 offset:25600
    v_mfma_f32_16x16x32_bf16 v[144:147], v[76:79], v[64:67], v[144:147]
    ds_read_b64_tr_b16 v[112:113], v233 offset:24576
    ds_read_b64_tr_b16 v[114:115], v233 offset:25600
    v_mfma_f32_16x16x32_bf16 v[148:151], v[76:79], v[68:71], v[148:151]
    ds_read_b64_tr_b16 v[116:117], v234 offset:24576
    ds_read_b64_tr_b16 v[118:119], v234 offset:25600
    v_mfma_f32_16x16x32_bf16 v[152:155], v[80:83], v[64:67], v[152:155]
    ds_read_b64_tr_b16 v[120:121], v235 offset:24576
    ds_read_b64_tr_b16 v[122:123], v235 offset:25600
    v_mfma_f32_16x16x32_bf16 v[156:159], v[80:83], v[68:71], v[156:159]
    ds_read_b64_tr_b16 v[124:125], v236 offset:24576
    ds_read_b64_tr_b16 v[126:127], v236 offset:25600
    v_mfma_f32_16x16x32_bf16 v[160:163], v[84:87], v[64:67], v[160:163]
    ds_read_b64_tr_b16 v[128:129], v237 offset:24576
    ds_read_b64_tr_b16 v[130:131], v237 offset:25600
    v_mfma_f32_16x16x32_bf16 v[164:167], v[84:87], v[68:71], v[164:167]
    v_mfma_f32_16x16x32_bf16 v[168:171], v[88:91], v[64:67], v[168:171]
    v_mfma_f32_16x16x32_bf16 v[172:175], v[88:91], v[68:71], v[172:175]
    v_mfma_f32_16x16x32_bf16 v[176:179], v[92:95], v[64:67], v[176:179]
    v_mfma_f32_16x16x32_bf16 v[180:183], v[92:95], v[68:71], v[180:183]
    v_mfma_f32_16x16x32_bf16 v[192:195], v[228:231], v[64:67], v[192:195]
    v_mfma_f32_16x16x32_bf16 v[196:199], v[64:67], v[64:67], v[196:199]
    s_waitcnt lgkmcnt(0)
    s_barrier
    v_and_b32 v4, 3, v2
    v_lshrrev_b32 v5, 2, v2
    v_cmp_eq_u32 s[40:41], 1, v4
    v_cmp_eq_u32 s[50:51], 2, v4
    v_cmp_eq_u32 s[56:57], 3, v4
    v_cmp_eq_u32 s[58:59], v5, v3
    v_cmp_eq_u32 s[60:61], 0, v2

    s_cmp_lg_u32 s47, 0
    s_cbranch_scc1 K1_CS_0_7_1
    v_mfma_f32_16x16x32_bf16 v[200:203], v[72:75], v[228:231], v[200:203]
    v_mfma_f32_16x16x32_bf16 v[204:207], v[88:91], v[228:231], v[204:207]
    v_mfma_f32_16x16x32_bf16 v[200:203], v[108:111], v[228:231], v[200:203]
    v_mfma_f32_16x16x32_bf16 v[204:207], v[124:127], v[228:231], v[204:207]
    s_branch K1_CS_0_7_e
K1_CS_0_7_1:
    s_cmp_lg_u32 s47, 1
    s_cbranch_scc1 K1_CS_0_7_2
    v_mfma_f32_16x16x32_bf16 v[200:203], v[76:79], v[228:231], v[200:203]
    v_mfma_f32_16x16x32_bf16 v[204:207], v[92:95], v[228:231], v[204:207]
    v_mfma_f32_16x16x32_bf16 v[200:203], v[112:115], v[228:231], v[200:203]
    v_mfma_f32_16x16x32_bf16 v[204:207], v[128:131], v[228:231], v[204:207]
    s_branch K1_CS_0_7_e
K1_CS_0_7_2:
    s_cmp_lg_u32 s47, 2
    s_cbranch_scc1 K1_CS_0_7_3
    v_mfma_f32_16x16x32_bf16 v[200:203], v[80:83], v[228:231], v[200:203]
    v_mfma_f32_16x16x32_bf16 v[200:203], v[116:119], v[228:231], v[200:203]
    s_branch K1_CS_0_7_e
K1_CS_0_7_3:
    v_mfma_f32_16x16x32_bf16 v[200:203], v[84:87], v[228:231], v[200:203]
    v_mfma_f32_16x16x32_bf16 v[200:203], v[120:123], v[228:231], v[200:203]
K1_CS_0_7_e:
    v_mfma_f32_16x16x32_bf16 v[192:195], v[228:231], v[100:103], v[192:195]
    v_mfma_f32_16x16x32_bf16 v[196:199], v[100:103], v[100:103], v[196:199]
    v_mfma_f32_16x16x32_bf16 v[136:139], v[108:111], v[100:103], v[136:139]
    v_mfma_f32_16x16x32_bf16 v[140:143], v[108:111], v[104:107], v[140:143]
    v_mfma_f32_16x16x32_bf16 v[144:147], v[112:115], v[100:103], v[144:147]
    v_mfma_f32_16x16x32_bf16 v[148:151], v[112:115], v[104:107], v[148:151]
    v_mfma_f32_16x16x32_bf16 v[152:155], v[116:119], v[100:103], v[152:155]
    v_mfma_f32_16x16x32_bf16 v[156:159], v[116:119], v[104:107], v[156:159]
    s_mov_b64 exec, s[60:61]
    ds_write_b128 v34, v[200:203]
    ds_write_b128 v34, v[204:207] offset:256
    s_mov_b64 exec, -1

    v_mfma_f32_16x16x32_bf16 v[160:163], v[120:123], v[100:103], v[160:163]
    v_mfma_f32_16x16x32_bf16 v[164:167], v[120:123], v[104:107], v[164:167]
    v_cndmask_b32 v7, v196, v197, s[40:41]
    v_cndmask_b32 v7, v7, v198, s[50:51]
    v_cndmask_b32 v7, v7, v199, s[56:57]
    v_mov_b32 v6, v192
    s_mov_b64 exec, s[58:59]
    ds_write_b64 v33, v[6:7]
    s_mov_b64 exec, -1
    ds_read_b64_tr_b16 v[56:57], v38
    ds_read_b64_tr_b16 v[58:59], v38 offset:512
    s_nop 1

    v_mfma_f32_16x16x32_bf16 v[168:171], v[124:127], v[100:103], v[168:171]
    v_mfma_f32_16x16x32_bf16 v[172:175], v[124:127], v[104:107], v[172:175]
    v_mfma_f32_16x16x32_bf16 v[176:179], v[128:131], v[100:103], v[176:179]
    v_mfma_f32_16x16x32_bf16 v[180:183], v[128:131], v[104:107], v[180:183]
    s_waitcnt lgkmcnt(0)
    s_barrier

    ds_read_b64 v[4:5], v33
    ds_read_b64 v[6:7], v35

    ds_read_b128 v[64:67], v36 offset:0
    ds_read_b128 v[68:71], v36 offset:64
    ds_read_b128 v[72:75], v36 offset:128
    ds_read_b128 v[76:79], v36 offset:192
    ds_read_b128 v[80:83], v36 offset:256
    ds_read_b128 v[84:87], v36 offset:320
    s_waitcnt lgkmcnt(6)
    v_mul_f32 v4, 0x3b000000, v4
    v_mul_f32 v5, 0x3b000000, v5
    v_mul_f32 v6, 0x3b000000, v6
    v_mul_f32 v7, 0x3b000000, v7
    v_fma_f32 v5, -v4, v4, v5
    v_fma_f32 v7, -v6, v6, v7
    v_max_f32 v5, 0, v5
    v_max_f32 v7, 0, v7
    v_add_f32 v5, 0x3727c5ac, v5
    v_add_f32 v7, 0x3727c5ac, v7
    v_rsq_f32 v60, v5
    v_rsq_f32 v61, v7
    v_sub_f32 v20, 0, v4
    v_sub_f32 v21, 0, v6
    v_mul_f32 v62, v20, v60
    v_mul_f32 v63, v21, v61
    v_mul_f32 v22, s55, v60
    v_mul_f32 v23, s55, v61
    s_waitcnt lgkmcnt(0)

    s_lshl_b32 s50, s42, 5
    s_lshl_b32 s51, s45, 1
    s_add_u32 s50, s50, s51
    s_lshl_b32 s50, s50, 10
    s_add_u32 s60, s50, 8388608
    s_add_u32 s61, s60, 32768
    s_lshl_b32 s50, s47, 10
    s_add_u32 s50, s50, 24576
    v_lshlrev_b32 v39, 3, v1
    v_add_u32 v39, s50, v39

    s_lshl_b32 s50, s47, 5
    v_add_u32 v4, s50, v2
    v_lshlrev_b32 v5, 3, v3
    v_lshl_add_u32 v6, v4, 6, v5
    v_lshl_add_u32 v7, v4, 5, v5

    v_fma_f32 v140, v21, v64, v140
    v_fma_f32 v141, v21, v65, v141
    v_fma_f32 v142, v21, v66, v142
    v_fma_f32 v143, v21, v67, v143
    v_cvt_pk_bf16_f32 v194, v140, v141
    v_cvt_pk_bf16_f32 v195, v142, v143
    ds_write_b64 v39, v[194:195] offset:0
    v_fma_f32 v148, v21, v68, v148
    v_fma_f32 v149, v21, v69, v149
    v_fma_f32 v150, v21, v70, v150
    v_fma_f32 v151, v21, v71, v151
    v_cvt_pk_bf16_f32 v198, v148, v149
    v_cvt_pk_bf16_f32 v199, v150, v151
    ds_write_b64 v39, v[198:199] offset:512
    v_fma_f32 v152, v20, v72, v152
    v_fma_f32 v153, v20, v73, v153
    v_fma_f32 v154, v20, v74, v154
    v_fma_f32 v155, v20, v75, v155
    v_cvt_pk_bf16_f32 v200, v152, v153
    v_cvt_pk_bf16_f32 v201, v154, v155
    v_fma_f32 v156, v21, v72, v156
    v_fma_f32 v157, v21, v73, v157
    v_fma_f32 v158, v21, v74, v158
    v_fma_f32 v159, v21, v75, v159
    v_cvt_pk_bf16_f32 v202, v156, v157
    v_cvt_pk_bf16_f32 v203, v158, v159
    v_fma_f32 v160, v20, v76, v160
    v_fma_f32 v161, v20, v77, v161
    v_fma_f32 v162, v20, v78, v162
    v_fma_f32 v163, v20, v79, v163
    v_cvt_pk_bf16_f32 v204, v160, v161
    v_cvt_pk_bf16_f32 v205, v162, v163
    v_fma_f32 v164, v21, v76, v164
    v_fma_f32 v165, v21, v77, v165
    v_fma_f32 v166, v21, v78, v166
    v_fma_f32 v167, v21, v79, v167
    v_cvt_pk_bf16_f32 v206, v164, v165
    v_cvt_pk_bf16_f32 v207, v166, v167
    v_mfma_f32_16x16x16_bf16 v[152:155], v[56:57], v[200:201], 0
    v_mfma_f32_16x16x16_bf16 v[156:159], v[56:57], v[202:203], 0
    v_mfma_f32_16x16x16_bf16 v[160:163], v[58:59], v[204:205], 0
    v_mfma_f32_16x16x16_bf16 v[164:167], v[58:59], v[206:207], 0
    v_fma_f32 v168, v20, v80, v168
    v_fma_f32 v169, v20, v81, v169
    v_fma_f32 v170, v20, v82, v170
    v_fma_f32 v171, v20, v83, v171
    v_mul_f32 v168, v168, v60
    v_mul_f32 v169, v169, v60
    v_mul_f32 v170, v170, v60
    v_mul_f32 v171, v171, v60
    v_cvt_pk_bf16_f32 v208, v168, v169
    v_cvt_pk_bf16_f32 v209, v170, v171
    v_fma_f32 v172, v21, v80, v172
    v_fma_f32 v173, v21, v81, v173
    v_fma_f32 v174, v21, v82, v174
    v_fma_f32 v175, v21, v83, v175
    v_mul_f32 v172, v172, v61
    v_mul_f32 v173, v173, v61
    v_mul_f32 v174, v174, v61
    v_mul_f32 v175, v175, v61
    v_cvt_pk_bf16_f32 v210, v172, v173
    v_cvt_pk_bf16_f32 v211, v174, v175
    v_fma_f32 v176, v20, v84, v176
    v_fma_f32 v177, v20, v85, v177
    v_fma_f32 v178, v20, v86, v178
    v_fma_f32 v179, v20, v87, v179
    v_mul_f32 v176, v176, v60
    v_mul_f32 v177, v177, v60
    v_mul_f32 v178, v178, v60
    v_mul_f32 v179, v179, v60
    v_cvt_pk_bf16_f32 v212, v176, v177
    v_cvt_pk_bf16_f32 v213, v178, v179
    v_fma_f32 v180, v21, v84, v180
    v_fma_f32 v181, v21, v85, v181
    v_fma_f32 v182, v21, v86, v182
    v_fma_f32 v183, v21, v87, v183
    v_mul_f32 v180, v180, v61
    v_mul_f32 v181, v181, v61
    v_mul_f32 v182, v182, v61
    v_mul_f32 v183, v183, v61
    v_cvt_pk_bf16_f32 v214, v180, v181
    v_cvt_pk_bf16_f32 v215, v182, v183
    ds_write_b64 v7, v[208:209] offset:16384
    ds_write_b64 v7, v[210:211] offset:16896
    ds_write_b64 v7, v[212:213] offset:20480
    ds_write_b64 v7, v[214:215] offset:20992
    s_waitcnt lgkmcnt(4)
    s_barrier
    v_max3_f32 v96, v152, v153, v154
    v_max3_f32 v108, v156, v157, v158
    v_max3_f32 v120, v160, v161, v162
    v_max3_f32 v132, v164, v165, v166
    v_max3_f32 v97, -v152, -v153, -v154
    v_max3_f32 v109, -v156, -v157, -v158
    v_max3_f32 v121, -v160, -v161, -v162
    v_max3_f32 v133, -v164, -v165, -v166
    v_max_f32 v96, v96, v155
    v_max_f32 v108, v108, v159
    v_max_f32 v120, v120, v163
    v_max_f32 v132, v132, v167
    v_max_f32_e64 v97, v97, -v155
    v_max_f32_e64 v109, v109, -v159
    v_max_f32_e64 v121, v121, -v163
    v_max_f32_e64 v133, v133, -v167
    v_permlane32_swap_b32 v96, v97
    v_permlane32_swap_b32 v108, v109
    v_permlane32_swap_b32 v120, v121
    v_permlane32_swap_b32 v132, v133
    v_max_f32 v98, v96, v97
    v_max_f32 v110, v108, v109
    v_max_f32 v122, v120, v121
    v_max_f32 v134, v132, v133
    v_mov_b32 v99, v98
    v_mov_b32 v111, v110
    v_mov_b32 v123, v122
    v_mov_b32 v135, v134
    v_permlane16_swap_b32 v98, v99
    v_permlane16_swap_b32 v110, v111
    v_permlane16_swap_b32 v122, v123
    v_permlane16_swap_b32 v134, v135
    v_max_f32 v96, v98, v99
    v_max_f32 v108, v110, v111
    v_max_f32 v120, v122, v123
    v_max_f32 v132, v134, v135
    v_mov_b32 v97, v96
    v_mov_b32 v109, v108
    v_mov_b32 v121, v120
    v_mov_b32 v133, v132
    v_permlane32_swap_b32 v96, v97
    v_permlane32_swap_b32 v108, v109
    v_permlane32_swap_b32 v120, v121
    v_permlane32_swap_b32 v132, v133
    v_mul_f32 v96, v22, v96
    v_mul_f32 v108, v23, v108
    v_mul_f32 v120, v22, v120
    v_mul_f32 v132, v23, v132
    v_mul_f32 v97, v22, v97
    v_mul_f32 v109, v23, v109
    v_mul_f32 v121, v22, v121
    v_mul_f32 v133, v23, v133
    v_fma_f32 v88, v152, v22, -v96
    v_fma_f32 v100, v156, v23, -v108
    v_fma_f32 v112, v160, v22, -v120
    v_fma_f32 v124, v164, v23, -v132
    v_fma_f32 v92, -v152, v22, -v97
    v_fma_f32 v104, -v156, v23, -v109
    v_fma_f32 v116, -v160, v22, -v121
    v_fma_f32 v128, -v164, v23, -v133
    v_fma_f32 v89, v153, v22, -v96
    v_fma_f32 v101, v157, v23, -v108
    v_fma_f32 v113, v161, v22, -v120
    v_fma_f32 v125, v165, v23, -v132
    v_fma_f32 v93, -v153, v22, -v97
    v_fma_f32 v105, -v157, v23, -v109
    v_fma_f32 v117, -v161, v22, -v121
    v_fma_f32 v129, -v165, v23, -v133
    v_fma_f32 v90, v154, v22, -v96
    v_fma_f32 v102, v158, v23, -v108
    v_fma_f32 v114, v162, v22, -v120
    v_fma_f32 v126, v166, v23, -v132
    v_fma_f32 v94, -v154, v22, -v97
    v_fma_f32 v106, -v158, v23, -v109
    v_fma_f32 v118, -v162, v22, -v121
    v_fma_f32 v130, -v166, v23, -v133
    v_fma_f32 v91, v155, v22, -v96
    v_fma_f32 v103, v159, v23, -v108
    v_fma_f32 v115, v163, v22, -v120
    v_fma_f32 v127, v167, v23, -v132
    v_fma_f32 v95, -v155, v22, -v97
    v_fma_f32 v107, -v159, v23, -v109
    v_fma_f32 v119, -v163, v22, -v121
    v_fma_f32 v131, -v167, v23, -v133
    v_exp_f32 v88, v88
    v_exp_f32 v100, v100
    v_exp_f32 v112, v112
    v_exp_f32 v124, v124
    v_exp_f32 v89, v89
    v_exp_f32 v101, v101
    v_exp_f32 v113, v113
    v_exp_f32 v125, v125
    v_exp_f32 v90, v90
    v_exp_f32 v102, v102
    v_exp_f32 v114, v114
    v_exp_f32 v126, v126
    v_exp_f32 v91, v91
    v_exp_f32 v103, v103
    v_exp_f32 v115, v115
    v_exp_f32 v127, v127
    v_exp_f32 v92, v92
    v_exp_f32 v104, v104
    v_exp_f32 v116, v116
    v_exp_f32 v128, v128
    v_exp_f32 v93, v93
    v_exp_f32 v105, v105
    v_exp_f32 v117, v117
    v_exp_f32 v129, v129
    v_exp_f32 v94, v94
    v_exp_f32 v106, v106
    v_exp_f32 v118, v118
    v_exp_f32 v130, v130
    v_exp_f32 v95, v95
    v_exp_f32 v107, v107
    v_exp_f32 v119, v119
    v_exp_f32 v131, v131
    v_add_f32 v96, v88, v89
    v_add_f32 v108, v100, v101
    v_add_f32 v120, v112, v113
    v_add_f32 v132, v124, v125
    v_add_f32 v97, v92, v93
    v_add_f32 v109, v104, v105
    v_add_f32 v121, v116, v117
    v_add_f32 v133, v128, v129
    v_add_f32 v98, v90, v91
    v_add_f32 v110, v102, v103
    v_add_f32 v122, v114, v115
    v_add_f32 v134, v126, v127
    v_add_f32 v99, v94, v95
    v_add_f32 v111, v106, v107
    v_add_f32 v123, v118, v119
    v_add_f32 v135, v130, v131
    v_add_f32 v96, v96, v98
    v_add_f32 v108, v108, v110
    v_add_f32 v120, v120, v122
    v_add_f32 v132, v132, v134
    v_add_f32 v97, v97, v99
    v_add_f32 v109, v109, v111
    v_add_f32 v121, v121, v123
    v_add_f32 v133, v133, v135
    v_permlane32_swap_b32 v96, v97
    v_permlane32_swap_b32 v108, v109
    v_permlane32_swap_b32 v120, v121
    v_permlane32_swap_b32 v132, v133
    v_add_f32 v98, v96, v97
    v_add_f32 v110, v108, v109
    v_add_f32 v122, v120, v121
    v_add_f32 v134, v132, v133
    v_mov_b32 v99, v98
    v_mov_b32 v111, v110
    v_mov_b32 v123, v122
    v_mov_b32 v135, v134
    v_permlane16_swap_b32 v98, v99
    v_permlane16_swap_b32 v110, v111
    v_permlane16_swap_b32 v122, v123
    v_permlane16_swap_b32 v134, v135
    v_add_f32 v96, v98, v99
    v_add_f32 v108, v110, v111
    v_add_f32 v120, v122, v123
    v_add_f32 v132, v134, v135
    v_mov_b32 v97, v96
    v_mov_b32 v109, v108
    v_mov_b32 v121, v120
    v_mov_b32 v133, v132
    v_permlane32_swap_b32 v96, v97
    v_permlane32_swap_b32 v108, v109
    v_permlane32_swap_b32 v120, v121
    v_permlane32_swap_b32 v132, v133
    v_rcp_f32 v96, v96
    v_rcp_f32 v108, v108
    v_rcp_f32 v120, v120
    v_rcp_f32 v132, v132
    v_rcp_f32 v97, v97
    v_rcp_f32 v109, v109
    v_rcp_f32 v121, v121
    v_rcp_f32 v133, v133
    v_mul_f32 v88, v88, v96
    v_mul_f32 v100, v100, v108
    v_mul_f32 v112, v112, v120
    v_mul_f32 v124, v124, v132
    v_mul_f32 v92, v92, v97
    v_mul_f32 v104, v104, v109
    v_mul_f32 v116, v116, v121
    v_mul_f32 v128, v128, v133
    v_mul_f32 v89, v89, v96
    v_mul_f32 v101, v101, v108
    v_mul_f32 v113, v113, v120
    v_mul_f32 v125, v125, v132
    v_mul_f32 v93, v93, v97
    v_mul_f32 v105, v105, v109
    v_mul_f32 v117, v117, v121
    v_mul_f32 v129, v129, v133
    v_mul_f32 v90, v90, v96
    v_mul_f32 v102, v102, v108
    v_mul_f32 v114, v114, v120
    v_mul_f32 v126, v126, v132
    v_mul_f32 v94, v94, v97
    v_mul_f32 v106, v106, v109
    v_mul_f32 v118, v118, v121
    v_mul_f32 v130, v130, v133
    v_mul_f32 v91, v91, v96
    v_mul_f32 v103, v103, v108
    v_mul_f32 v115, v115, v120
    v_mul_f32 v127, v127, v132
    v_mul_f32 v95, v95, v97
    v_mul_f32 v107, v107, v109
    v_mul_f32 v119, v119, v121
    v_mul_f32 v131, v131, v133
    v_cvt_pk_bf16_f32 v216, v88, v89
    v_cvt_pk_bf16_f32 v220, v100, v101
    v_cvt_pk_bf16_f32 v224, v112, v113
    v_cvt_pk_bf16_f32 v228, v124, v125
    v_cvt_pk_bf16_f32 v217, v90, v91
    v_cvt_pk_bf16_f32 v221, v102, v103
    v_cvt_pk_bf16_f32 v225, v114, v115
    v_cvt_pk_bf16_f32 v229, v126, v127
    v_cvt_pk_bf16_f32 v218, v92, v93
    v_cvt_pk_bf16_f32 v222, v104, v105
    v_cvt_pk_bf16_f32 v226, v116, v117
    v_cvt_pk_bf16_f32 v230, v128, v129
    v_cvt_pk_bf16_f32 v219, v94, v95
    v_cvt_pk_bf16_f32 v223, v106, v107
    v_cvt_pk_bf16_f32 v227, v118, v119
    v_cvt_pk_bf16_f32 v231, v130, v131
    ds_write_b64 v6, v[216:217] offset:0
    ds_write_b64 v6, v[218:219] offset:32
    ds_write_b64 v6, v[220:221] offset:1024
    ds_write_b64 v6, v[222:223] offset:1056
    ds_write_b64 v6, v[224:225] offset:8192
    ds_write_b64 v6, v[226:227] offset:8224
    ds_write_b64 v6, v[228:229] offset:9216
    ds_write_b64 v6, v[230:231] offset:9248
    v_fma_f32 v136, v20, v64, v136
    v_fma_f32 v137, v20, v65, v137
    v_fma_f32 v138, v20, v66, v138
    v_fma_f32 v139, v20, v67, v139
    v_cvt_pk_bf16_f32 v192, v136, v137
    v_cvt_pk_bf16_f32 v193, v138, v139
    v_fma_f32 v144, v20, v68, v144
    v_fma_f32 v145, v20, v69, v145
    v_fma_f32 v146, v20, v70, v146
    v_fma_f32 v147, v20, v71, v147
    v_cvt_pk_bf16_f32 v196, v144, v145
    v_cvt_pk_bf16_f32 v197, v146, v147
    v_mfma_f32_16x16x16_bf16 v[136:139], v[56:57], v[192:193], 0
    s_nop 0
    v_mfma_f32_16x16x16_bf16 v[144:147], v[58:59], v[196:197], 0
    s_waitcnt lgkmcnt(0)
    s_barrier
    s_nop 3
    v_max3_f32 v96, v136, v137, v138
    s_nop 0
    v_max3_f32 v108, v144, v145, v146
    v_max3_f32 v97, -v136, -v137, -v138
    v_max3_f32 v109, -v144, -v145, -v146
    v_max_f32 v96, v96, v139
    v_max_f32 v108, v108, v147
    v_max_f32_e64 v97, v97, -v139
    v_max_f32_e64 v109, v109, -v147
    s_nop 0
    v_permlane32_swap_b32 v96, v97
    v_permlane32_swap_b32 v108, v109
    v_max_f32 v98, v96, v97
    v_max_f32 v110, v108, v109
    v_mov_b32 v99, v98
    v_mov_b32 v111, v110
    s_nop 0
    v_permlane16_swap_b32 v98, v99
    v_permlane16_swap_b32 v110, v111
    v_max_f32 v96, v98, v99
    v_max_f32 v108, v110, v111
    v_mov_b32 v97, v96
    v_mov_b32 v109, v108
    s_nop 0
    v_permlane32_swap_b32 v96, v97
    v_permlane32_swap_b32 v108, v109
    v_mul_f32 v96, v22, v96
    v_mul_f32 v108, v22, v108
    v_mul_f32 v97, v22, v97
    v_mul_f32 v109, v22, v109
    v_fma_f32 v88, v136, v22, -v96
    v_fma_f32 v100, v144, v22, -v108
    v_fma_f32 v92, -v136, v22, -v97
    v_fma_f32 v104, -v144, v22, -v109
    v_fma_f32 v89, v137, v22, -v96
    v_fma_f32 v101, v145, v22, -v108
    v_fma_f32 v93, -v137, v22, -v97
    v_fma_f32 v105, -v145, v22, -v109
    v_fma_f32 v90, v138, v22, -v96
    v_fma_f32 v102, v146, v22, -v108
    v_fma_f32 v94, -v138, v22, -v97
    v_fma_f32 v106, -v146, v22, -v109
    v_fma_f32 v91, v139, v22, -v96
    v_fma_f32 v103, v147, v22, -v108
    v_fma_f32 v95, -v139, v22, -v97
    v_fma_f32 v107, -v147, v22, -v109
    v_exp_f32 v88, v88
    v_exp_f32 v100, v100
    v_exp_f32 v89, v89
    v_exp_f32 v101, v101
    v_exp_f32 v90, v90
    v_exp_f32 v102, v102
    v_exp_f32 v91, v91
    v_exp_f32 v103, v103
    v_exp_f32 v92, v92
    v_exp_f32 v104, v104
    v_exp_f32 v93, v93
    v_exp_f32 v105, v105
    v_exp_f32 v94, v94
    v_exp_f32 v106, v106
    v_exp_f32 v95, v95
    v_exp_f32 v107, v107
    v_add_f32 v96, v88, v89
    v_add_f32 v108, v100, v101
    v_add_f32 v97, v92, v93
    v_add_f32 v109, v104, v105
    v_add_f32 v98, v90, v91
    v_add_f32 v110, v102, v103
    v_add_f32 v99, v94, v95
    v_add_f32 v111, v106, v107
    v_add_f32 v96, v96, v98
    v_add_f32 v108, v108, v110
    v_add_f32 v97, v97, v99
    v_add_f32 v109, v109, v111
    s_nop 0
    v_permlane32_swap_b32 v96, v97
    v_permlane32_swap_b32 v108, v109
    v_add_f32 v98, v96, v97
    v_add_f32 v110, v108, v109
    v_mov_b32 v99, v98
    v_mov_b32 v111, v110
    s_nop 0
    v_permlane16_swap_b32 v98, v99
    v_permlane16_swap_b32 v110, v111
    v_add_f32 v96, v98, v99
    v_add_f32 v108, v110, v111
    v_mov_b32 v97, v96
    v_mov_b32 v109, v108
    s_nop 0
    v_permlane32_swap_b32 v96, v97
    v_permlane32_swap_b32 v108, v109
    v_rcp_f32 v96, v96
    v_rcp_f32 v108, v108
    v_rcp_f32 v97, v97
    v_rcp_f32 v109, v109
    v_mul_f32 v88, v88, v96
    v_mul_f32 v100, v100, v108
    v_mul_f32 v92, v92, v97
    v_mul_f32 v104, v104, v109
    v_mul_f32 v89, v89, v96
    v_mul_f32 v101, v101, v108
    v_mul_f32 v93, v93, v97
    v_mul_f32 v105, v105, v109
    v_mul_f32 v90, v90, v96
    v_mul_f32 v102, v102, v108
    v_mul_f32 v94, v94, v97
    v_mul_f32 v106, v106, v109
    v_mul_f32 v91, v91, v96
    v_mul_f32 v103, v103, v108
    v_mul_f32 v95, v95, v97
    v_mul_f32 v107, v107, v109
    v_cvt_pk_bf16_f32 v168, v88, v89
    v_cvt_pk_bf16_f32 v172, v100, v101
    v_cvt_pk_bf16_f32 v169, v90, v91
    v_cvt_pk_bf16_f32 v173, v102, v103
    v_cvt_pk_bf16_f32 v170, v92, v93
    v_cvt_pk_bf16_f32 v174, v104, v105
    v_cvt_pk_bf16_f32 v171, v94, v95
    v_cvt_pk_bf16_f32 v175, v106, v107
    buffer_store_dwordx4 v[168:171], v37, s[32:35], s60 offen offset:0 sc0 sc1
    buffer_store_dwordx4 v[172:175], v37, s[32:35], s60 offen offset:1024 sc0 sc1
    s_branch K1_END
K1_HPATH:
    s_nop 4
    s_mul_i32 s50, s45, 224
    s_lshl_b32 s51, s43, 5
    s_add_u32 s51, s51, s50
    v_lshlrev_b32 v4, 3, v3
    v_add_u32 v5, s51, v4
    s_mul_i32 s51, s43, 192
    s_sub_u32 s51, 192, s51
    s_add_u32 s51, s51, s50
    v_add_u32 v6, s51, v4

    buffer_load_dwordx2 v[40:41], v5, s[36:39], 0 offen offset:0
    buffer_load_dwordx2 v[42:43], v5, s[36:39], 0 offen offset:32
    buffer_load_dwordx2 v[44:45], v5, s[36:39], 0 offen offset:64
    buffer_load_dwordx2 v[46:47], v5, s[36:39], 0 offen offset:96
    buffer_load_dwordx2 v[48:49], v5, s[36:39], 0 offen offset:128
    buffer_load_dwordx2 v[50:51], v5, s[36:39], 0 offen offset:160
    buffer_load_dwordx2 v[52:53], v6, s[36:39], 0 offen
    s_waitcnt vmcnt(15)
    s_barrier
    ds_read_b128 v[64:67], v16 offset:0
    ds_read_b128 v[68:71], v18 offset:0
    ds_read_b64_tr_b16 v[72:73], v232 offset:0
    ds_read_b64_tr_b16 v[74:75], v232 offset:1024
    ds_read_b64_tr_b16 v[76:77], v233 offset:0
    ds_read_b64_tr_b16 v[78:79], v233 offset:1024
    ds_read_b64_tr_b16 v[80:81], v234 offset:0
    ds_read_b64_tr_b16 v[82:83], v234 offset:1024
    ds_read_b64_tr_b16 v[84:85], v235 offset:0
    ds_read_b64_tr_b16 v[86:87], v235 offset:1024
    ds_read_b64_tr_b16 v[88:89], v236 offset:0
    ds_read_b64_tr_b16 v[90:91], v236 offset:1024
    ds_read_b64_tr_b16 v[92:93], v237 offset:0
    ds_read_b64_tr_b16 v[94:95], v237 offset:1024
    ds_read_b64_tr_b16 v[96:97], v238 offset:0
    ds_read_b64_tr_b16 v[98:99], v238 offset:1024
    s_waitcnt lgkmcnt(0)
    v_mfma_f32_16x16x32_bf16 v[136:139], v[72:75], v[64:67], v[136:139]
    ds_read_b128 v[100:103], v17 offset:0
    ds_read_b128 v[104:107], v19 offset:0
    v_mfma_f32_16x16x32_bf16 v[140:143], v[72:75], v[68:71], v[140:143]
    ds_read_b64_tr_b16 v[108:109], v232 offset:8192
    ds_read_b64_tr_b16 v[110:111], v232 offset:9216
    v_mfma_f32_16x16x32_bf16 v[144:147], v[76:79], v[64:67], v[144:147]
    ds_read_b64_tr_b16 v[112:113], v233 offset:8192
    ds_read_b64_tr_b16 v[114:115], v233 offset:9216
    v_mfma_f32_16x16x32_bf16 v[148:151], v[76:79], v[68:71], v[148:151]
    ds_read_b64_tr_b16 v[116:117], v234 offset:8192
    ds_read_b64_tr_b16 v[118:119], v234 offset:9216
    v_mfma_f32_16x16x32_bf16 v[152:155], v[80:83], v[64:67], v[152:155]
    ds_read_b64_tr_b16 v[120:121], v235 offset:8192
    ds_read_b64_tr_b16 v[122:123], v235 offset:9216
    v_mfma_f32_16x16x32_bf16 v[156:159], v[80:83], v[68:71], v[156:159]
    ds_read_b64_tr_b16 v[124:125], v236 offset:8192
    ds_read_b64_tr_b16 v[126:127], v236 offset:9216
    v_mfma_f32_16x16x32_bf16 v[160:163], v[84:87], v[64:67], v[160:163]
    ds_read_b64_tr_b16 v[128:129], v237 offset:8192
    ds_read_b64_tr_b16 v[130:131], v237 offset:9216
    v_mfma_f32_16x16x32_bf16 v[164:167], v[84:87], v[68:71], v[164:167]
    ds_read_b64_tr_b16 v[132:133], v238 offset:8192
    ds_read_b64_tr_b16 v[134:135], v238 offset:9216
    v_mfma_f32_16x16x32_bf16 v[168:171], v[88:91], v[64:67], v[168:171]
    s_movk_i32 s57, 256
    s_add_u32 m0, s54, 32768
    s_nop 0
    buffer_load_dwordx4 v10, s[20:23], s57 offen lds
    s_add_u32 m0, s54, 33792
    s_nop 0
    buffer_load_dwordx4 v11, s[20:23], s57 offen lds
    v_mfma_f32_16x16x32_bf16 v[172:175], v[88:91], v[68:71], v[172:175]
    s_mov_b32 s58, 393216
    s_add_u32 m0, s54, 81920
    s_nop 0
    buffer_load_dwordx4 v12, s[24:27], s58 offen lds
    s_add_u32 m0, s54, 82944
    s_nop 0
    buffer_load_dwordx4 v13, s[24:27], s58 offen lds
    v_mfma_f32_16x16x32_bf16 v[176:179], v[92:95], v[64:67], v[176:179]
    s_mov_b32 s59, 458752
    s_add_u32 m0, s54, 131072
    s_nop 0
    buffer_load_dwordx4 v14, s[28:31], s59 offen lds
    s_add_u32 m0, s54, 132096
    s_nop 0
    buffer_load_dwordx4 v15, s[28:31], s59 offen lds
    v_mfma_f32_16x16x32_bf16 v[180:183], v[92:95], v[68:71], v[180:183]
    v_mfma_f32_16x16x32_bf16 v[184:187], v[96:99], v[64:67], v[184:187]
    v_mfma_f32_16x16x32_bf16 v[188:191], v[96:99], v[68:71], v[188:191]
    v_mfma_f32_16x16x32_bf16 v[192:195], v[228:231], v[64:67], v[192:195]
    v_mfma_f32_16x16x32_bf16 v[196:199], v[64:67], v[64:67], v[196:199]
    s_waitcnt vmcnt(15) lgkmcnt(0)
    s_barrier
    s_cmp_lg_u32 s47, 0
    s_cbranch_scc1 K1_CS_1_0_1
    v_mfma_f32_16x16x32_bf16 v[200:203], v[72:75], v[228:231], v[200:203]
    v_mfma_f32_16x16x32_bf16 v[204:207], v[88:91], v[228:231], v[204:207]
    v_mfma_f32_16x16x32_bf16 v[200:203], v[108:111], v[228:231], v[200:203]
    v_mfma_f32_16x16x32_bf16 v[204:207], v[124:127], v[228:231], v[204:207]
    s_branch K1_CS_1_0_e
K1_CS_1_0_1:
    s_cmp_lg_u32 s47, 1
    s_cbranch_scc1 K1_CS_1_0_2
    v_mfma_f32_16x16x32_bf16 v[200:203], v[76:79], v[228:231], v[200:203]
    v_mfma_f32_16x16x32_bf16 v[204:207], v[92:95], v[228:231], v[204:207]
    v_mfma_f32_16x16x32_bf16 v[200:203], v[112:115], v[228:231], v[200:203]
    v_mfma_f32_16x16x32_bf16 v[204:207], v[128:131], v[228:231], v[204:207]
    s_branch K1_CS_1_0_e
K1_CS_1_0_2:
    s_cmp_lg_u32 s47, 2
    s_cbranch_scc1 K1_CS_1_0_3
    v_mfma_f32_16x16x32_bf16 v[200:203], v[80:83], v[228:231], v[200:203]
    v_mfma_f32_16x16x32_bf16 v[204:207], v[96:99], v[228:231], v[204:207]
    v_mfma_f32_16x16x32_bf16 v[200:203], v[116:119], v[228:231], v[200:203]
    v_mfma_f32_16x16x32_bf16 v[204:207], v[132:135], v[228:231], v[204:207]
    s_branch K1_CS_1_0_e
K1_CS_1_0_3:
    v_mfma_f32_16x16x32_bf16 v[200:203], v[84:87], v[228:231], v[200:203]
    v_mfma_f32_16x16x32_bf16 v[200:203], v[120:123], v[228:231], v[200:203]
K1_CS_1_0_e:
    v_mfma_f32_16x16x32_bf16 v[136:139], v[108:111], v[100:103], v[136:139]
    ds_read_b128 v[64:67], v16 offset:16384
    ds_read_b128 v[68:71], v18 offset:16384
    v_mfma_f32_16x16x32_bf16 v[140:143], v[108:111], v[104:107], v[140:143]
    ds_read_b64_tr_b16 v[72:73], v232 offset:16384
    ds_read_b64_tr_b16 v[74:75], v232 offset:17408
    v_mfma_f32_16x16x32_bf16 v[144:147], v[112:115], v[100:103], v[144:147]
    ds_read_b64_tr_b16 v[76:77], v233 offset:16384
    ds_read_b64_tr_b16 v[78:79], v233 offset:17408
    v_mfma_f32_16x16x32_bf16 v[148:151], v[112:115], v[104:107], v[148:151]
    ds_read_b64_tr_b16 v[80:81], v234 offset:16384
    ds_read_b64_tr_b16 v[82:83], v234 offset:17408
    v_mfma_f32_16x16x32_bf16 v[152:155], v[116:119], v[100:103], v[152:155]
    ds_read_b64_tr_b16 v[84:85], v235 offset:16384
    ds_read_b64_tr_b16 v[86:87], v235 offset:17408
    v_mfma_f32_16x16x32_bf16 v[156:159], v[116:119], v[104:107], v[156:159]
    ds_read_b64_tr_b16 v[88:89], v236 offset:16384
    ds_read_b64_tr_b16 v[90:91], v236 offset:17408
    v_mfma_f32_16x16x32_bf16 v[160:163], v[120:123], v[100:103], v[160:163]
    ds_read_b64_tr_b16 v[92:93], v237 offset:16384
    ds_read_b64_tr_b16 v[94:95], v237 offset:17408
    v_mfma_f32_16x16x32_bf16 v[164:167], v[120:123], v[104:107], v[164:167]
    ds_read_b64_tr_b16 v[96:97], v238 offset:16384
    ds_read_b64_tr_b16 v[98:99], v238 offset:17408
    v_mfma_f32_16x16x32_bf16 v[168:171], v[124:127], v[100:103], v[168:171]
    s_movk_i32 s57, 384
    s_add_u32 m0, s54, 0
    s_nop 0
    buffer_load_dwordx4 v10, s[20:23], s57 offen lds
    s_add_u32 m0, s54, 1024
    s_nop 0
    buffer_load_dwordx4 v11, s[20:23], s57 offen lds
    v_mfma_f32_16x16x32_bf16 v[172:175], v[124:127], v[104:107], v[172:175]
    s_mov_b32 s58, 589824
    s_add_u32 m0, s54, 49152
    s_nop 0
    buffer_load_dwordx4 v12, s[24:27], s58 offen lds
    s_add_u32 m0, s54, 50176
    s_nop 0
    buffer_load_dwordx4 v13, s[24:27], s58 offen lds
    v_mfma_f32_16x16x32_bf16 v[176:179], v[128:131], v[100:103], v[176:179]
    s_mov_b32 s59, 688128
    s_add_u32 m0, s54, 98304
    s_nop 0
    buffer_load_dwordx4 v14, s[28:31], s59 offen lds
    s_add_u32 m0, s54, 99328
    s_nop 0
    buffer_load_dwordx4 v15, s[28:31], s59 offen lds
    v_mfma_f32_16x16x32_bf16 v[180:183], v[128:131], v[104:107], v[180:183]
    v_mfma_f32_16x16x32_bf16 v[184:187], v[132:135], v[100:103], v[184:187]
    v_mfma_f32_16x16x32_bf16 v[188:191], v[132:135], v[104:107], v[188:191]
    v_mfma_f32_16x16x32_bf16 v[192:195], v[228:231], v[100:103], v[192:195]
    v_mfma_f32_16x16x32_bf16 v[196:199], v[100:103], v[100:103], v[196:199]
    s_waitcnt lgkmcnt(0)
    v_mfma_f32_16x16x32_bf16 v[136:139], v[72:75], v[64:67], v[136:139]
    ds_read_b128 v[100:103], v17 offset:16384
    ds_read_b128 v[104:107], v19 offset:16384
    v_mfma_f32_16x16x32_bf16 v[140:143], v[72:75], v[68:71], v[140:143]
    ds_read_b64_tr_b16 v[108:109], v232 offset:24576
    ds_read_b64_tr_b16 v[110:111], v232 offset:25600
    v_mfma_f32_16x16x32_bf16 v[144:147], v[76:79], v[64:67], v[144:147]
    ds_read_b64_tr_b16 v[112:113], v233 offset:24576
    ds_read_b64_tr_b16 v[114:115], v233 offset:25600
    v_mfma_f32_16x16x32_bf16 v[148:151], v[76:79], v[68:71], v[148:151]
    ds_read_b64_tr_b16 v[116:117], v234 offset:24576
    ds_read_b64_tr_b16 v[118:119], v234 offset:25600
    v_mfma_f32_16x16x32_bf16 v[152:155], v[80:83], v[64:67], v[152:155]
    ds_read_b64_tr_b16 v[120:121], v235 offset:24576
    ds_read_b64_tr_b16 v[122:123], v235 offset:25600
    v_mfma_f32_16x16x32_bf16 v[156:159], v[80:83], v[68:71], v[156:159]
    ds_read_b64_tr_b16 v[124:125], v236 offset:24576
    ds_read_b64_tr_b16 v[126:127], v236 offset:25600
    v_mfma_f32_16x16x32_bf16 v[160:163], v[84:87], v[64:67], v[160:163]
    ds_read_b64_tr_b16 v[128:129], v237 offset:24576
    ds_read_b64_tr_b16 v[130:131], v237 offset:25600
    v_mfma_f32_16x16x32_bf16 v[164:167], v[84:87], v[68:71], v[164:167]
    ds_read_b64_tr_b16 v[132:133], v238 offset:24576
    ds_read_b64_tr_b16 v[134:135], v238 offset:25600
    v_mfma_f32_16x16x32_bf16 v[168:171], v[88:91], v[64:67], v[168:171]
    v_mfma_f32_16x16x32_bf16 v[172:175], v[88:91], v[68:71], v[172:175]
    v_mfma_f32_16x16x32_bf16 v[176:179], v[92:95], v[64:67], v[176:179]
    v_mfma_f32_16x16x32_bf16 v[180:183], v[92:95], v[68:71], v[180:183]
    v_mfma_f32_16x16x32_bf16 v[184:187], v[96:99], v[64:67], v[184:187]
    v_mfma_f32_16x16x32_bf16 v[188:191], v[96:99], v[68:71], v[188:191]
    v_mfma_f32_16x16x32_bf16 v[192:195], v[228:231], v[64:67], v[192:195]
    v_mfma_f32_16x16x32_bf16 v[196:199], v[64:67], v[64:67], v[196:199]
    s_waitcnt vmcnt(6) lgkmcnt(0)
    s_barrier
    s_cmp_lg_u32 s47, 0
    s_cbranch_scc1 K1_CS_1_1_1
    v_mfma_f32_16x16x32_bf16 v[200:203], v[72:75], v[228:231], v[200:203]
    v_mfma_f32_16x16x32_bf16 v[204:207], v[88:91], v[228:231], v[204:207]
    v_mfma_f32_16x16x32_bf16 v[200:203], v[108:111], v[228:231], v[200:203]
    v_mfma_f32_16x16x32_bf16 v[204:207], v[124:127], v[228:231], v[204:207]
    s_branch K1_CS_1_1_e
K1_CS_1_1_1:
    s_cmp_lg_u32 s47, 1
    s_cbranch_scc1 K1_CS_1_1_2
    v_mfma_f32_16x16x32_bf16 v[200:203], v[76:79], v[228:231], v[200:203]
    v_mfma_f32_16x16x32_bf16 v[204:207], v[92:95], v[228:231], v[204:207]
    v_mfma_f32_16x16x32_bf16 v[200:203], v[112:115], v[228:231], v[200:203]
    v_mfma_f32_16x16x32_bf16 v[204:207], v[128:131], v[228:231], v[204:207]
    s_branch K1_CS_1_1_e
K1_CS_1_1_2:
    s_cmp_lg_u32 s47, 2
    s_cbranch_scc1 K1_CS_1_1_3
    v_mfma_f32_16x16x32_bf16 v[200:203], v[80:83], v[228:231], v[200:203]
    v_mfma_f32_16x16x32_bf16 v[204:207], v[96:99], v[228:231], v[204:207]
    v_mfma_f32_16x16x32_bf16 v[200:203], v[116:119], v[228:231], v[200:203]
    v_mfma_f32_16x16x32_bf16 v[204:207], v[132:135], v[228:231], v[204:207]
    s_branch K1_CS_1_1_e
K1_CS_1_1_3:
    v_mfma_f32_16x16x32_bf16 v[200:203], v[84:87], v[228:231], v[200:203]
    v_mfma_f32_16x16x32_bf16 v[200:203], v[120:123], v[228:231], v[200:203]
K1_CS_1_1_e:
    v_mfma_f32_16x16x32_bf16 v[136:139], v[108:111], v[100:103], v[136:139]
    ds_read_b128 v[64:67], v16 offset:32768
    ds_read_b128 v[68:71], v18 offset:32768
    v_mfma_f32_16x16x32_bf16 v[140:143], v[108:111], v[104:107], v[140:143]
    ds_read_b64_tr_b16 v[72:73], v232 offset:32768
    ds_read_b64_tr_b16 v[74:75], v232 offset:33792
    v_mfma_f32_16x16x32_bf16 v[144:147], v[112:115], v[100:103], v[144:147]
    ds_read_b64_tr_b16 v[76:77], v233 offset:32768
    ds_read_b64_tr_b16 v[78:79], v233 offset:33792
    v_mfma_f32_16x16x32_bf16 v[148:151], v[112:115], v[104:107], v[148:151]
    ds_read_b64_tr_b16 v[80:81], v234 offset:32768
    ds_read_b64_tr_b16 v[82:83], v234 offset:33792
    v_mfma_f32_16x16x32_bf16 v[152:155], v[116:119], v[100:103], v[152:155]
    ds_read_b64_tr_b16 v[84:85], v235 offset:32768
    ds_read_b64_tr_b16 v[86:87], v235 offset:33792
    v_mfma_f32_16x16x32_bf16 v[156:159], v[116:119], v[104:107], v[156:159]
    ds_read_b64_tr_b16 v[88:89], v236 offset:32768
    ds_read_b64_tr_b16 v[90:91], v236 offset:33792
    v_mfma_f32_16x16x32_bf16 v[160:163], v[120:123], v[100:103], v[160:163]
    ds_read_b64_tr_b16 v[92:93], v237 offset:32768
    ds_read_b64_tr_b16 v[94:95], v237 offset:33792
    v_mfma_f32_16x16x32_bf16 v[164:167], v[120:123], v[104:107], v[164:167]
    ds_read_b64_tr_b16 v[96:97], v238 offset:32768
    ds_read_b64_tr_b16 v[98:99], v238 offset:33792
    v_mfma_f32_16x16x32_bf16 v[168:171], v[124:127], v[100:103], v[168:171]
    s_movk_i32 s57, 512
    s_add_u32 m0, s54, 16384
    s_nop 0
    buffer_load_dwordx4 v10, s[20:23], s57 offen lds
    s_add_u32 m0, s54, 17408
    s_nop 0
    buffer_load_dwordx4 v11, s[20:23], s57 offen lds
    v_mfma_f32_16x16x32_bf16 v[172:175], v[124:127], v[104:107], v[172:175]
    s_mov_b32 s58, 786432
    s_add_u32 m0, s54, 65536
    s_nop 0
    buffer_load_dwordx4 v12, s[24:27], s58 offen lds
    s_add_u32 m0, s54, 66560
    s_nop 0
    buffer_load_dwordx4 v13, s[24:27], s58 offen lds
    v_mfma_f32_16x16x32_bf16 v[176:179], v[128:131], v[100:103], v[176:179]
    s_mov_b32 s59, 917504
    s_add_u32 m0, s54, 114688
    s_nop 0
    buffer_load_dwordx4 v14, s[28:31], s59 offen lds
    s_add_u32 m0, s54, 115712
    s_nop 0
    buffer_load_dwordx4 v15, s[28:31], s59 offen lds
    v_mfma_f32_16x16x32_bf16 v[180:183], v[128:131], v[104:107], v[180:183]
    v_mfma_f32_16x16x32_bf16 v[184:187], v[132:135], v[100:103], v[184:187]
    v_mfma_f32_16x16x32_bf16 v[188:191], v[132:135], v[104:107], v[188:191]
    v_mfma_f32_16x16x32_bf16 v[192:195], v[228:231], v[100:103], v[192:195]
    v_mfma_f32_16x16x32_bf16 v[196:199], v[100:103], v[100:103], v[196:199]
    s_waitcnt lgkmcnt(0)
    v_mfma_f32_16x16x32_bf16 v[136:139], v[72:75], v[64:67], v[136:139]
    ds_read_b128 v[100:103], v17 offset:32768
    ds_read_b128 v[104:107], v19 offset:32768
    v_mfma_f32_16x16x32_bf16 v[140:143], v[72:75], v[68:71], v[140:143]
    ds_read_b64_tr_b16 v[108:109], v232 offset:40960
    ds_read_b64_tr_b16 v[110:111], v232 offset:41984
    v_mfma_f32_16x16x32_bf16 v[144:147], v[76:79], v[64:67], v[144:147]
    ds_read_b64_tr_b16 v[112:113], v233 offset:40960
    ds_read_b64_tr_b16 v[114:115], v233 offset:41984
    v_mfma_f32_16x16x32_bf16 v[148:151], v[76:79], v[68:71], v[148:151]
    ds_read_b64_tr_b16 v[116:117], v234 offset:40960
    ds_read_b64_tr_b16 v[118:119], v234 offset:41984
    v_mfma_f32_16x16x32_bf16 v[152:155], v[80:83], v[64:67], v[152:155]
    ds_read_b64_tr_b16 v[120:121], v235 offset:40960
    ds_read_b64_tr_b16 v[122:123], v235 offset:41984
    v_mfma_f32_16x16x32_bf16 v[156:159], v[80:83], v[68:71], v[156:159]
    ds_read_b64_tr_b16 v[124:125], v236 offset:40960
    ds_read_b64_tr_b16 v[126:127], v236 offset:41984
    v_mfma_f32_16x16x32_bf16 v[160:163], v[84:87], v[64:67], v[160:163]
    ds_read_b64_tr_b16 v[128:129], v237 offset:40960
    ds_read_b64_tr_b16 v[130:131], v237 offset:41984
    v_mfma_f32_16x16x32_bf16 v[164:167], v[84:87], v[68:71], v[164:167]
    ds_read_b64_tr_b16 v[132:133], v238 offset:40960
    ds_read_b64_tr_b16 v[134:135], v238 offset:41984
    v_mfma_f32_16x16x32_bf16 v[168:171], v[88:91], v[64:67], v[168:171]
    v_mfma_f32_16x16x32_bf16 v[172:175], v[88:91], v[68:71], v[172:175]
    v_mfma_f32_16x16x32_bf16 v[176:179], v[92:95], v[64:67], v[176:179]
    v_mfma_f32_16x16x32_bf16 v[180:183], v[92:95], v[68:71], v[180:183]
    v_mfma_f32_16x16x32_bf16 v[184:187], v[96:99], v[64:67], v[184:187]
    v_mfma_f32_16x16x32_bf16 v[188:191], v[96:99], v[68:71], v[188:191]
    v_mfma_f32_16x16x32_bf16 v[192:195], v[228:231], v[64:67], v[192:195]
    v_mfma_f32_16x16x32_bf16 v[196:199], v[64:67], v[64:67], v[196:199]
    s_waitcnt vmcnt(6) lgkmcnt(0)
    s_barrier
    s_cmp_lg_u32 s47, 0
    s_cbranch_scc1 K1_CS_1_2_1
    v_mfma_f32_16x16x32_bf16 v[200:203], v[72:75], v[228:231], v[200:203]
    v_mfma_f32_16x16x32_bf16 v[204:207], v[88:91], v[228:231], v[204:207]
    v_mfma_f32_16x16x32_bf16 v[200:203], v[108:111], v[228:231], v[200:203]
    v_mfma_f32_16x16x32_bf16 v[204:207], v[124:127], v[228:231], v[204:207]
    s_branch K1_CS_1_2_e
K1_CS_1_2_1:
    s_cmp_lg_u32 s47, 1
    s_cbranch_scc1 K1_CS_1_2_2
    v_mfma_f32_16x16x32_bf16 v[200:203], v[76:79], v[228:231], v[200:203]
    v_mfma_f32_16x16x32_bf16 v[204:207], v[92:95], v[228:231], v[204:207]
    v_mfma_f32_16x16x32_bf16 v[200:203], v[112:115], v[228:231], v[200:203]
    v_mfma_f32_16x16x32_bf16 v[204:207], v[128:131], v[228:231], v[204:207]
    s_branch K1_CS_1_2_e
K1_CS_1_2_2:
    s_cmp_lg_u32 s47, 2
    s_cbranch_scc1 K1_CS_1_2_3
    v_mfma_f32_16x16x32_bf16 v[200:203], v[80:83], v[228:231], v[200:203]
    v_mfma_f32_16x16x32_bf16 v[204:207], v[96:99], v[228:231], v[204:207]
    v_mfma_f32_16x16x32_bf16 v[200:203], v[116:119], v[228:231], v[200:203]
    v_mfma_f32_16x16x32_bf16 v[204:207], v[132:135], v[228:231], v[204:207]
    s_branch K1_CS_1_2_e
K1_CS_1_2_3:
    v_mfma_f32_16x16x32_bf16 v[200:203], v[84:87], v[228:231], v[200:203]
    v_mfma_f32_16x16x32_bf16 v[200:203], v[120:123], v[228:231], v[200:203]
K1_CS_1_2_e:
    v_mfma_f32_16x16x32_bf16 v[136:139], v[108:111], v[100:103], v[136:139]
    ds_read_b128 v[64:67], v16 offset:0
    ds_read_b128 v[68:71], v18 offset:0
    v_mfma_f32_16x16x32_bf16 v[140:143], v[108:111], v[104:107], v[140:143]
    ds_read_b64_tr_b16 v[72:73], v232 offset:0
    ds_read_b64_tr_b16 v[74:75], v232 offset:1024
    v_mfma_f32_16x16x32_bf16 v[144:147], v[112:115], v[100:103], v[144:147]
    ds_read_b64_tr_b16 v[76:77], v233 offset:0
    ds_read_b64_tr_b16 v[78:79], v233 offset:1024
    v_mfma_f32_16x16x32_bf16 v[148:151], v[112:115], v[104:107], v[148:151]
    ds_read_b64_tr_b16 v[80:81], v234 offset:0
    ds_read_b64_tr_b16 v[82:83], v234 offset:1024
    v_mfma_f32_16x16x32_bf16 v[152:155], v[116:119], v[100:103], v[152:155]
    ds_read_b64_tr_b16 v[84:85], v235 offset:0
    ds_read_b64_tr_b16 v[86:87], v235 offset:1024
    v_mfma_f32_16x16x32_bf16 v[156:159], v[116:119], v[104:107], v[156:159]
    ds_read_b64_tr_b16 v[88:89], v236 offset:0
    ds_read_b64_tr_b16 v[90:91], v236 offset:1024
    v_mfma_f32_16x16x32_bf16 v[160:163], v[120:123], v[100:103], v[160:163]
    ds_read_b64_tr_b16 v[92:93], v237 offset:0
    ds_read_b64_tr_b16 v[94:95], v237 offset:1024
    v_mfma_f32_16x16x32_bf16 v[164:167], v[120:123], v[104:107], v[164:167]
    ds_read_b64_tr_b16 v[96:97], v238 offset:0
    ds_read_b64_tr_b16 v[98:99], v238 offset:1024
    v_mfma_f32_16x16x32_bf16 v[168:171], v[124:127], v[100:103], v[168:171]
    s_movk_i32 s57, 640
    s_add_u32 m0, s54, 32768
    s_nop 0
    buffer_load_dwordx4 v10, s[20:23], s57 offen lds
    s_add_u32 m0, s54, 33792
    s_nop 0
    buffer_load_dwordx4 v11, s[20:23], s57 offen lds
    v_mfma_f32_16x16x32_bf16 v[172:175], v[124:127], v[104:107], v[172:175]
    s_mov_b32 s58, 983040
    s_add_u32 m0, s54, 81920
    s_nop 0
    buffer_load_dwordx4 v12, s[24:27], s58 offen lds
    s_add_u32 m0, s54, 82944
    s_nop 0
    buffer_load_dwordx4 v13, s[24:27], s58 offen lds
    v_mfma_f32_16x16x32_bf16 v[176:179], v[128:131], v[100:103], v[176:179]
    s_mov_b32 s59, 1146880
    s_add_u32 m0, s54, 131072
    s_nop 0
    buffer_load_dwordx4 v14, s[28:31], s59 offen lds
    s_add_u32 m0, s54, 132096
    s_nop 0
    buffer_load_dwordx4 v15, s[28:31], s59 offen lds
    v_mfma_f32_16x16x32_bf16 v[180:183], v[128:131], v[104:107], v[180:183]
    v_mfma_f32_16x16x32_bf16 v[184:187], v[132:135], v[100:103], v[184:187]
    v_mfma_f32_16x16x32_bf16 v[188:191], v[132:135], v[104:107], v[188:191]
    v_mfma_f32_16x16x32_bf16 v[192:195], v[228:231], v[100:103], v[192:195]
    v_mfma_f32_16x16x32_bf16 v[196:199], v[100:103], v[100:103], v[196:199]
    s_waitcnt lgkmcnt(0)
    v_mfma_f32_16x16x32_bf16 v[136:139], v[72:75], v[64:67], v[136:139]
    ds_read_b128 v[100:103], v17 offset:0
    ds_read_b128 v[104:107], v19 offset:0
    v_mfma_f32_16x16x32_bf16 v[140:143], v[72:75], v[68:71], v[140:143]
    ds_read_b64_tr_b16 v[108:109], v232 offset:8192
    ds_read_b64_tr_b16 v[110:111], v232 offset:9216
    v_mfma_f32_16x16x32_bf16 v[144:147], v[76:79], v[64:67], v[144:147]
    ds_read_b64_tr_b16 v[112:113], v233 offset:8192
    ds_read_b64_tr_b16 v[114:115], v233 offset:9216
    v_mfma_f32_16x16x32_bf16 v[148:151], v[76:79], v[68:71], v[148:151]
    ds_read_b64_tr_b16 v[116:117], v234 offset:8192
    ds_read_b64_tr_b16 v[118:119], v234 offset:9216
    v_mfma_f32_16x16x32_bf16 v[152:155], v[80:83], v[64:67], v[152:155]
    ds_read_b64_tr_b16 v[120:121], v235 offset:8192
    ds_read_b64_tr_b16 v[122:123], v235 offset:9216
    v_mfma_f32_16x16x32_bf16 v[156:159], v[80:83], v[68:71], v[156:159]
    ds_read_b64_tr_b16 v[124:125], v236 offset:8192
    ds_read_b64_tr_b16 v[126:127], v236 offset:9216
    v_mfma_f32_16x16x32_bf16 v[160:163], v[84:87], v[64:67], v[160:163]
    ds_read_b64_tr_b16 v[128:129], v237 offset:8192
    ds_read_b64_tr_b16 v[130:131], v237 offset:9216
    v_mfma_f32_16x16x32_bf16 v[164:167], v[84:87], v[68:71], v[164:167]
    ds_read_b64_tr_b16 v[132:133], v238 offset:8192
    ds_read_b64_tr_b16 v[134:135], v238 offset:9216
    v_mfma_f32_16x16x32_bf16 v[168:171], v[88:91], v[64:67], v[168:171]
    v_mfma_f32_16x16x32_bf16 v[172:175], v[88:91], v[68:71], v[172:175]
    v_mfma_f32_16x16x32_bf16 v[176:179], v[92:95], v[64:67], v[176:179]
    v_mfma_f32_16x16x32_bf16 v[180:183], v[92:95], v[68:71], v[180:183]
    v_mfma_f32_16x16x32_bf16 v[184:187], v[96:99], v[64:67], v[184:187]
    v_mfma_f32_16x16x32_bf16 v[188:191], v[96:99], v[68:71], v[188:191]
    v_mfma_f32_16x16x32_bf16 v[192:195], v[228:231], v[64:67], v[192:195]
    v_mfma_f32_16x16x32_bf16 v[196:199], v[64:67], v[64:67], v[196:199]
    s_waitcnt vmcnt(6) lgkmcnt(0)
    s_barrier
    s_cmp_lg_u32 s47, 0
    s_cbranch_scc1 K1_CS_1_3_1
    v_mfma_f32_16x16x32_bf16 v[200:203], v[72:75], v[228:231], v[200:203]
    v_mfma_f32_16x16x32_bf16 v[204:207], v[88:91], v[228:231], v[204:207]
    v_mfma_f32_16x16x32_bf16 v[200:203], v[108:111], v[228:231], v[200:203]
    v_mfma_f32_16x16x32_bf16 v[204:207], v[124:127], v[228:231], v[204:207]
    s_branch K1_CS_1_3_e
K1_CS_1_3_1:
    s_cmp_lg_u32 s47, 1
    s_cbranch_scc1 K1_CS_1_3_2
    v_mfma_f32_16x16x32_bf16 v[200:203], v[76:79], v[228:231], v[200:203]
    v_mfma_f32_16x16x32_bf16 v[204:207], v[92:95], v[228:231], v[204:207]
    v_mfma_f32_16x16x32_bf16 v[200:203], v[112:115], v[228:231], v[200:203]
    v_mfma_f32_16x16x32_bf16 v[204:207], v[128:131], v[228:231], v[204:207]
    s_branch K1_CS_1_3_e
K1_CS_1_3_2:
    s_cmp_lg_u32 s47, 2
    s_cbranch_scc1 K1_CS_1_3_3
    v_mfma_f32_16x16x32_bf16 v[200:203], v[80:83], v[228:231], v[200:203]
    v_mfma_f32_16x16x32_bf16 v[204:207], v[96:99], v[228:231], v[204:207]
    v_mfma_f32_16x16x32_bf16 v[200:203], v[116:119], v[228:231], v[200:203]
    v_mfma_f32_16x16x32_bf16 v[204:207], v[132:135], v[228:231], v[204:207]
    s_branch K1_CS_1_3_e
K1_CS_1_3_3:
    v_mfma_f32_16x16x32_bf16 v[200:203], v[84:87], v[228:231], v[200:203]
    v_mfma_f32_16x16x32_bf16 v[200:203], v[120:123], v[228:231], v[200:203]
K1_CS_1_3_e:
    v_mfma_f32_16x16x32_bf16 v[136:139], v[108:111], v[100:103], v[136:139]
    ds_read_b128 v[64:67], v16 offset:16384
    ds_read_b128 v[68:71], v18 offset:16384
    v_mfma_f32_16x16x32_bf16 v[140:143], v[108:111], v[104:107], v[140:143]
    ds_read_b64_tr_b16 v[72:73], v232 offset:16384
    ds_read_b64_tr_b16 v[74:75], v232 offset:17408
    v_mfma_f32_16x16x32_bf16 v[144:147], v[112:115], v[100:103], v[144:147]
    ds_read_b64_tr_b16 v[76:77], v233 offset:16384
    ds_read_b64_tr_b16 v[78:79], v233 offset:17408
    v_mfma_f32_16x16x32_bf16 v[148:151], v[112:115], v[104:107], v[148:151]
    ds_read_b64_tr_b16 v[80:81], v234 offset:16384
    ds_read_b64_tr_b16 v[82:83], v234 offset:17408
    v_mfma_f32_16x16x32_bf16 v[152:155], v[116:119], v[100:103], v[152:155]
    ds_read_b64_tr_b16 v[84:85], v235 offset:16384
    ds_read_b64_tr_b16 v[86:87], v235 offset:17408
    v_mfma_f32_16x16x32_bf16 v[156:159], v[116:119], v[104:107], v[156:159]
    ds_read_b64_tr_b16 v[88:89], v236 offset:16384
    ds_read_b64_tr_b16 v[90:91], v236 offset:17408
    v_mfma_f32_16x16x32_bf16 v[160:163], v[120:123], v[100:103], v[160:163]
    ds_read_b64_tr_b16 v[92:93], v237 offset:16384
    ds_read_b64_tr_b16 v[94:95], v237 offset:17408
    v_mfma_f32_16x16x32_bf16 v[164:167], v[120:123], v[104:107], v[164:167]
    ds_read_b64_tr_b16 v[96:97], v238 offset:16384
    ds_read_b64_tr_b16 v[98:99], v238 offset:17408
    v_mfma_f32_16x16x32_bf16 v[168:171], v[124:127], v[100:103], v[168:171]
    s_movk_i32 s57, 768
    s_add_u32 m0, s54, 0
    s_nop 0
    buffer_load_dwordx4 v10, s[20:23], s57 offen lds
    s_add_u32 m0, s54, 1024
    s_nop 0
    buffer_load_dwordx4 v11, s[20:23], s57 offen lds
    v_mfma_f32_16x16x32_bf16 v[172:175], v[124:127], v[104:107], v[172:175]
    s_mov_b32 s58, 1179648
    s_add_u32 m0, s54, 49152
    s_nop 0
    buffer_load_dwordx4 v12, s[24:27], s58 offen lds
    s_add_u32 m0, s54, 50176
    s_nop 0
    buffer_load_dwordx4 v13, s[24:27], s58 offen lds
    v_mfma_f32_16x16x32_bf16 v[176:179], v[128:131], v[100:103], v[176:179]
    s_mov_b32 s59, 1376256
    s_add_u32 m0, s54, 98304
    s_nop 0
    buffer_load_dwordx4 v14, s[28:31], s59 offen lds
    s_add_u32 m0, s54, 99328
    s_nop 0
    buffer_load_dwordx4 v15, s[28:31], s59 offen lds
    v_mfma_f32_16x16x32_bf16 v[180:183], v[128:131], v[104:107], v[180:183]
    v_mfma_f32_16x16x32_bf16 v[184:187], v[132:135], v[100:103], v[184:187]
    v_mfma_f32_16x16x32_bf16 v[188:191], v[132:135], v[104:107], v[188:191]
    v_mfma_f32_16x16x32_bf16 v[192:195], v[228:231], v[100:103], v[192:195]
    v_mfma_f32_16x16x32_bf16 v[196:199], v[100:103], v[100:103], v[196:199]
    s_waitcnt lgkmcnt(0)
    v_mfma_f32_16x16x32_bf16 v[136:139], v[72:75], v[64:67], v[136:139]
    ds_read_b128 v[100:103], v17 offset:16384
    ds_read_b128 v[104:107], v19 offset:16384
    v_mfma_f32_16x16x32_bf16 v[140:143], v[72:75], v[68:71], v[140:143]
    ds_read_b64_tr_b16 v[108:109], v232 offset:24576
    ds_read_b64_tr_b16 v[110:111], v232 offset:25600
    v_mfma_f32_16x16x32_bf16 v[144:147], v[76:79], v[64:67], v[144:147]
    ds_read_b64_tr_b16 v[112:113], v233 offset:24576
    ds_read_b64_tr_b16 v[114:115], v233 offset:25600
    v_mfma_f32_16x16x32_bf16 v[148:151], v[76:79], v[68:71], v[148:151]
    ds_read_b64_tr_b16 v[116:117], v234 offset:24576
    ds_read_b64_tr_b16 v[118:119], v234 offset:25600
    v_mfma_f32_16x16x32_bf16 v[152:155], v[80:83], v[64:67], v[152:155]
    ds_read_b64_tr_b16 v[120:121], v235 offset:24576
    ds_read_b64_tr_b16 v[122:123], v235 offset:25600
    v_mfma_f32_16x16x32_bf16 v[156:159], v[80:83], v[68:71], v[156:159]
    ds_read_b64_tr_b16 v[124:125], v236 offset:24576
    ds_read_b64_tr_b16 v[126:127], v236 offset:25600
    v_mfma_f32_16x16x32_bf16 v[160:163], v[84:87], v[64:67], v[160:163]
    ds_read_b64_tr_b16 v[128:129], v237 offset:24576
    ds_read_b64_tr_b16 v[130:131], v237 offset:25600
    v_mfma_f32_16x16x32_bf16 v[164:167], v[84:87], v[68:71], v[164:167]
    ds_read_b64_tr_b16 v[132:133], v238 offset:24576
    ds_read_b64_tr_b16 v[134:135], v238 offset:25600
    v_mfma_f32_16x16x32_bf16 v[168:171], v[88:91], v[64:67], v[168:171]
    v_mfma_f32_16x16x32_bf16 v[172:175], v[88:91], v[68:71], v[172:175]
    v_mfma_f32_16x16x32_bf16 v[176:179], v[92:95], v[64:67], v[176:179]
    v_mfma_f32_16x16x32_bf16 v[180:183], v[92:95], v[68:71], v[180:183]
    v_mfma_f32_16x16x32_bf16 v[184:187], v[96:99], v[64:67], v[184:187]
    v_mfma_f32_16x16x32_bf16 v[188:191], v[96:99], v[68:71], v[188:191]
    v_mfma_f32_16x16x32_bf16 v[192:195], v[228:231], v[64:67], v[192:195]
    v_mfma_f32_16x16x32_bf16 v[196:199], v[64:67], v[64:67], v[196:199]
    s_waitcnt vmcnt(6) lgkmcnt(0)
    s_barrier
    s_cmp_lg_u32 s47, 0
    s_cbranch_scc1 K1_CS_1_4_1
    v_mfma_f32_16x16x32_bf16 v[200:203], v[72:75], v[228:231], v[200:203]
    v_mfma_f32_16x16x32_bf16 v[204:207], v[88:91], v[228:231], v[204:207]
    v_mfma_f32_16x16x32_bf16 v[200:203], v[108:111], v[228:231], v[200:203]
    v_mfma_f32_16x16x32_bf16 v[204:207], v[124:127], v[228:231], v[204:207]
    s_branch K1_CS_1_4_e
K1_CS_1_4_1:
    s_cmp_lg_u32 s47, 1
    s_cbranch_scc1 K1_CS_1_4_2
    v_mfma_f32_16x16x32_bf16 v[200:203], v[76:79], v[228:231], v[200:203]
    v_mfma_f32_16x16x32_bf16 v[204:207], v[92:95], v[228:231], v[204:207]
    v_mfma_f32_16x16x32_bf16 v[200:203], v[112:115], v[228:231], v[200:203]
    v_mfma_f32_16x16x32_bf16 v[204:207], v[128:131], v[228:231], v[204:207]
    s_branch K1_CS_1_4_e
K1_CS_1_4_2:
    s_cmp_lg_u32 s47, 2
    s_cbranch_scc1 K1_CS_1_4_3
    v_mfma_f32_16x16x32_bf16 v[200:203], v[80:83], v[228:231], v[200:203]
    v_mfma_f32_16x16x32_bf16 v[204:207], v[96:99], v[228:231], v[204:207]
    v_mfma_f32_16x16x32_bf16 v[200:203], v[116:119], v[228:231], v[200:203]
    v_mfma_f32_16x16x32_bf16 v[204:207], v[132:135], v[228:231], v[204:207]
    s_branch K1_CS_1_4_e
K1_CS_1_4_3:
    v_mfma_f32_16x16x32_bf16 v[200:203], v[84:87], v[228:231], v[200:203]
    v_mfma_f32_16x16x32_bf16 v[200:203], v[120:123], v[228:231], v[200:203]
K1_CS_1_4_e:
    v_mfma_f32_16x16x32_bf16 v[136:139], v[108:111], v[100:103], v[136:139]
    ds_read_b128 v[64:67], v16 offset:32768
    ds_read_b128 v[68:71], v18 offset:32768
    v_mfma_f32_16x16x32_bf16 v[140:143], v[108:111], v[104:107], v[140:143]
    ds_read_b64_tr_b16 v[72:73], v232 offset:32768
    ds_read_b64_tr_b16 v[74:75], v232 offset:33792
    v_mfma_f32_16x16x32_bf16 v[144:147], v[112:115], v[100:103], v[144:147]
    ds_read_b64_tr_b16 v[76:77], v233 offset:32768
    ds_read_b64_tr_b16 v[78:79], v233 offset:33792
    v_mfma_f32_16x16x32_bf16 v[148:151], v[112:115], v[104:107], v[148:151]
    ds_read_b64_tr_b16 v[80:81], v234 offset:32768
    ds_read_b64_tr_b16 v[82:83], v234 offset:33792
    v_mfma_f32_16x16x32_bf16 v[152:155], v[116:119], v[100:103], v[152:155]
    ds_read_b64_tr_b16 v[84:85], v235 offset:32768
    ds_read_b64_tr_b16 v[86:87], v235 offset:33792
    v_mfma_f32_16x16x32_bf16 v[156:159], v[116:119], v[104:107], v[156:159]
    ds_read_b64_tr_b16 v[88:89], v236 offset:32768
    ds_read_b64_tr_b16 v[90:91], v236 offset:33792
    v_mfma_f32_16x16x32_bf16 v[160:163], v[120:123], v[100:103], v[160:163]
    ds_read_b64_tr_b16 v[92:93], v237 offset:32768
    ds_read_b64_tr_b16 v[94:95], v237 offset:33792
    v_mfma_f32_16x16x32_bf16 v[164:167], v[120:123], v[104:107], v[164:167]
    ds_read_b64_tr_b16 v[96:97], v238 offset:32768
    ds_read_b64_tr_b16 v[98:99], v238 offset:33792
    v_mfma_f32_16x16x32_bf16 v[168:171], v[124:127], v[100:103], v[168:171]
    s_movk_i32 s57, 896
    s_add_u32 m0, s54, 16384
    s_nop 0
    buffer_load_dwordx4 v10, s[20:23], s57 offen lds
    s_add_u32 m0, s54, 17408
    s_nop 0
    buffer_load_dwordx4 v11, s[20:23], s57 offen lds
    v_mfma_f32_16x16x32_bf16 v[172:175], v[124:127], v[104:107], v[172:175]
    s_mov_b32 s58, 1376256
    s_add_u32 m0, s54, 65536
    s_nop 0
    buffer_load_dwordx4 v12, s[24:27], s58 offen lds
    s_add_u32 m0, s54, 66560
    s_nop 0
    buffer_load_dwordx4 v13, s[24:27], s58 offen lds
    v_mfma_f32_16x16x32_bf16 v[176:179], v[128:131], v[100:103], v[176:179]
    s_mov_b32 s59, 1605632
    s_add_u32 m0, s54, 114688
    s_nop 0
    buffer_load_dwordx4 v14, s[28:31], s59 offen lds
    s_add_u32 m0, s54, 115712
    s_nop 0
    buffer_load_dwordx4 v15, s[28:31], s59 offen lds
    v_mfma_f32_16x16x32_bf16 v[180:183], v[128:131], v[104:107], v[180:183]
    v_mfma_f32_16x16x32_bf16 v[184:187], v[132:135], v[100:103], v[184:187]
    v_mfma_f32_16x16x32_bf16 v[188:191], v[132:135], v[104:107], v[188:191]
    v_mfma_f32_16x16x32_bf16 v[192:195], v[228:231], v[100:103], v[192:195]
    v_mfma_f32_16x16x32_bf16 v[196:199], v[100:103], v[100:103], v[196:199]
    s_waitcnt lgkmcnt(0)
    v_mfma_f32_16x16x32_bf16 v[136:139], v[72:75], v[64:67], v[136:139]
    ds_read_b128 v[100:103], v17 offset:32768
    ds_read_b128 v[104:107], v19 offset:32768
    v_mfma_f32_16x16x32_bf16 v[140:143], v[72:75], v[68:71], v[140:143]
    ds_read_b64_tr_b16 v[108:109], v232 offset:40960
    ds_read_b64_tr_b16 v[110:111], v232 offset:41984
    v_mfma_f32_16x16x32_bf16 v[144:147], v[76:79], v[64:67], v[144:147]
    ds_read_b64_tr_b16 v[112:113], v233 offset:40960
    ds_read_b64_tr_b16 v[114:115], v233 offset:41984
    v_mfma_f32_16x16x32_bf16 v[148:151], v[76:79], v[68:71], v[148:151]
    ds_read_b64_tr_b16 v[116:117], v234 offset:40960
    ds_read_b64_tr_b16 v[118:119], v234 offset:41984
    v_mfma_f32_16x16x32_bf16 v[152:155], v[80:83], v[64:67], v[152:155]
    ds_read_b64_tr_b16 v[120:121], v235 offset:40960
    ds_read_b64_tr_b16 v[122:123], v235 offset:41984
    v_mfma_f32_16x16x32_bf16 v[156:159], v[80:83], v[68:71], v[156:159]
    ds_read_b64_tr_b16 v[124:125], v236 offset:40960
    ds_read_b64_tr_b16 v[126:127], v236 offset:41984
    v_mfma_f32_16x16x32_bf16 v[160:163], v[84:87], v[64:67], v[160:163]
    ds_read_b64_tr_b16 v[128:129], v237 offset:40960
    ds_read_b64_tr_b16 v[130:131], v237 offset:41984
    v_mfma_f32_16x16x32_bf16 v[164:167], v[84:87], v[68:71], v[164:167]
    ds_read_b64_tr_b16 v[132:133], v238 offset:40960
    ds_read_b64_tr_b16 v[134:135], v238 offset:41984
    v_mfma_f32_16x16x32_bf16 v[168:171], v[88:91], v[64:67], v[168:171]
    v_mfma_f32_16x16x32_bf16 v[172:175], v[88:91], v[68:71], v[172:175]
    v_mfma_f32_16x16x32_bf16 v[176:179], v[92:95], v[64:67], v[176:179]
    v_mfma_f32_16x16x32_bf16 v[180:183], v[92:95], v[68:71], v[180:183]
    v_mfma_f32_16x16x32_bf16 v[184:187], v[96:99], v[64:67], v[184:187]
    v_mfma_f32_16x16x32_bf16 v[188:191], v[96:99], v[68:71], v[188:191]
    v_mfma_f32_16x16x32_bf16 v[192:195], v[228:231], v[64:67], v[192:195]
    v_mfma_f32_16x16x32_bf16 v[196:199], v[64:67], v[64:67], v[196:199]
    s_waitcnt vmcnt(6) lgkmcnt(0)
    s_barrier
    s_cmp_lg_u32 s47, 0
    s_cbranch_scc1 K1_CS_1_5_1
    v_mfma_f32_16x16x32_bf16 v[200:203], v[72:75], v[228:231], v[200:203]
    v_mfma_f32_16x16x32_bf16 v[204:207], v[88:91], v[228:231], v[204:207]
    v_mfma_f32_16x16x32_bf16 v[200:203], v[108:111], v[228:231], v[200:203]
    v_mfma_f32_16x16x32_bf16 v[204:207], v[124:127], v[228:231], v[204:207]
    s_branch K1_CS_1_5_e
K1_CS_1_5_1:
    s_cmp_lg_u32 s47, 1
    s_cbranch_scc1 K1_CS_1_5_2
    v_mfma_f32_16x16x32_bf16 v[200:203], v[76:79], v[228:231], v[200:203]
    v_mfma_f32_16x16x32_bf16 v[204:207], v[92:95], v[228:231], v[204:207]
    v_mfma_f32_16x16x32_bf16 v[200:203], v[112:115], v[228:231], v[200:203]
    v_mfma_f32_16x16x32_bf16 v[204:207], v[128:131], v[228:231], v[204:207]
    s_branch K1_CS_1_5_e
K1_CS_1_5_2:
    s_cmp_lg_u32 s47, 2
    s_cbranch_scc1 K1_CS_1_5_3
    v_mfma_f32_16x16x32_bf16 v[200:203], v[80:83], v[228:231], v[200:203]
    v_mfma_f32_16x16x32_bf16 v[204:207], v[96:99], v[228:231], v[204:207]
    v_mfma_f32_16x16x32_bf16 v[200:203], v[116:119], v[228:231], v[200:203]
    v_mfma_f32_16x16x32_bf16 v[204:207], v[132:135], v[228:231], v[204:207]
    s_branch K1_CS_1_5_e
K1_CS_1_5_3:
    v_mfma_f32_16x16x32_bf16 v[200:203], v[84:87], v[228:231], v[200:203]
    v_mfma_f32_16x16x32_bf16 v[200:203], v[120:123], v[228:231], v[200:203]
K1_CS_1_5_e:
    v_mfma_f32_16x16x32_bf16 v[136:139], v[108:111], v[100:103], v[136:139]
    ds_read_b128 v[64:67], v16 offset:0
    ds_read_b128 v[68:71], v18 offset:0
    v_mfma_f32_16x16x32_bf16 v[140:143], v[108:111], v[104:107], v[140:143]
    ds_read_b64_tr_b16 v[72:73], v232 offset:0
    ds_read_b64_tr_b16 v[74:75], v232 offset:1024
    v_mfma_f32_16x16x32_bf16 v[144:147], v[112:115], v[100:103], v[144:147]
    ds_read_b64_tr_b16 v[76:77], v233 offset:0
    ds_read_b64_tr_b16 v[78:79], v233 offset:1024
    v_mfma_f32_16x16x32_bf16 v[148:151], v[112:115], v[104:107], v[148:151]
    ds_read_b64_tr_b16 v[80:81], v234 offset:0
    ds_read_b64_tr_b16 v[82:83], v234 offset:1024
    v_mfma_f32_16x16x32_bf16 v[152:155], v[116:119], v[100:103], v[152:155]
    ds_read_b64_tr_b16 v[84:85], v235 offset:0
    ds_read_b64_tr_b16 v[86:87], v235 offset:1024
    v_mfma_f32_16x16x32_bf16 v[156:159], v[116:119], v[104:107], v[156:159]
    ds_read_b64_tr_b16 v[88:89], v236 offset:0
    ds_read_b64_tr_b16 v[90:91], v236 offset:1024
    v_mfma_f32_16x16x32_bf16 v[160:163], v[120:123], v[100:103], v[160:163]
    ds_read_b64_tr_b16 v[92:93], v237 offset:0
    ds_read_b64_tr_b16 v[94:95], v237 offset:1024
    v_mfma_f32_16x16x32_bf16 v[164:167], v[120:123], v[104:107], v[164:167]
    ds_read_b64_tr_b16 v[96:97], v238 offset:0
    ds_read_b64_tr_b16 v[98:99], v238 offset:1024
    v_mfma_f32_16x16x32_bf16 v[168:171], v[124:127], v[100:103], v[168:171]
    v_mfma_f32_16x16x32_bf16 v[172:175], v[124:127], v[104:107], v[172:175]
    v_mfma_f32_16x16x32_bf16 v[176:179], v[128:131], v[100:103], v[176:179]
    v_mfma_f32_16x16x32_bf16 v[180:183], v[128:131], v[104:107], v[180:183]
    v_mfma_f32_16x16x32_bf16 v[184:187], v[132:135], v[100:103], v[184:187]
    v_mfma_f32_16x16x32_bf16 v[188:191], v[132:135], v[104:107], v[188:191]
    v_mfma_f32_16x16x32_bf16 v[192:195], v[228:231], v[100:103], v[192:195]
    v_mfma_f32_16x16x32_bf16 v[196:199], v[100:103], v[100:103], v[196:199]
    s_waitcnt lgkmcnt(0)
    v_mfma_f32_16x16x32_bf16 v[136:139], v[72:75], v[64:67], v[136:139]
    ds_read_b128 v[100:103], v17 offset:0
    ds_read_b128 v[104:107], v19 offset:0
    v_mfma_f32_16x16x32_bf16 v[140:143], v[72:75], v[68:71], v[140:143]
    ds_read_b64_tr_b16 v[108:109], v232 offset:8192
    ds_read_b64_tr_b16 v[110:111], v232 offset:9216
    v_mfma_f32_16x16x32_bf16 v[144:147], v[76:79], v[64:67], v[144:147]
    ds_read_b64_tr_b16 v[112:113], v233 offset:8192
    ds_read_b64_tr_b16 v[114:115], v233 offset:9216
    v_mfma_f32_16x16x32_bf16 v[148:151], v[76:79], v[68:71], v[148:151]
    ds_read_b64_tr_b16 v[116:117], v234 offset:8192
    ds_read_b64_tr_b16 v[118:119], v234 offset:9216
    v_mfma_f32_16x16x32_bf16 v[152:155], v[80:83], v[64:67], v[152:155]
    ds_read_b64_tr_b16 v[120:121], v235 offset:8192
    ds_read_b64_tr_b16 v[122:123], v235 offset:9216
    v_mfma_f32_16x16x32_bf16 v[156:159], v[80:83], v[68:71], v[156:159]
    ds_read_b64_tr_b16 v[124:125], v236 offset:8192
    ds_read_b64_tr_b16 v[126:127], v236 offset:9216
    v_mfma_f32_16x16x32_bf16 v[160:163], v[84:87], v[64:67], v[160:163]
    ds_read_b64_tr_b16 v[128:129], v237 offset:8192
    ds_read_b64_tr_b16 v[130:131], v237 offset:9216
    v_mfma_f32_16x16x32_bf16 v[164:167], v[84:87], v[68:71], v[164:167]
    ds_read_b64_tr_b16 v[132:133], v238 offset:8192
    ds_read_b64_tr_b16 v[134:135], v238 offset:9216
    v_mfma_f32_16x16x32_bf16 v[168:171], v[88:91], v[64:67], v[168:171]
    s_lshr_b32 s51, s2, 3
    v_lshlrev_b32 v4, 7, v1
    s_mul_i32 s40, s51, 57344
    s_lshl_b32 s41, s46, 13
    s_add_u32 s40, s40, s41
    s_lshl_b32 s41, s51, 14
    s_cmp_eq_u32 s46, 7
    s_cbranch_scc1 K1_PW_1_o
    buffer_load_dword v255, v4, s[68:71], s40 offen
    s_branch K1_PW_1_e
K1_PW_1_o:
    buffer_load_dword v255, v4, s[72:75], s41 offen
K1_PW_1_e:

    s_add_u32 s41, s41, 8192
    buffer_load_dword v255, v4, s[72:75], s41 offen

    v_mfma_f32_16x16x32_bf16 v[172:175], v[88:91], v[68:71], v[172:175]
    v_mfma_f32_16x16x32_bf16 v[176:179], v[92:95], v[64:67], v[176:179]
    v_mfma_f32_16x16x32_bf16 v[180:183], v[92:95], v[68:71], v[180:183]
    v_mfma_f32_16x16x32_bf16 v[184:187], v[96:99], v[64:67], v[184:187]
    v_mfma_f32_16x16x32_bf16 v[188:191], v[96:99], v[68:71], v[188:191]
    v_mfma_f32_16x16x32_bf16 v[192:195], v[228:231], v[64:67], v[192:195]
    v_mfma_f32_16x16x32_bf16 v[196:199], v[64:67], v[64:67], v[196:199]
    s_waitcnt vmcnt(2) lgkmcnt(0)
    s_barrier
    s_cmp_lg_u32 s47, 0
    s_cbranch_scc1 K1_CS_1_6_1
    v_mfma_f32_16x16x32_bf16 v[200:203], v[72:75], v[228:231], v[200:203]
    v_mfma_f32_16x16x32_bf16 v[204:207], v[88:91], v[228:231], v[204:207]
    v_mfma_f32_16x16x32_bf16 v[200:203], v[108:111], v[228:231], v[200:203]
    v_mfma_f32_16x16x32_bf16 v[204:207], v[124:127], v[228:231], v[204:207]
    s_branch K1_CS_1_6_e
K1_CS_1_6_1:
    s_cmp_lg_u32 s47, 1
    s_cbranch_scc1 K1_CS_1_6_2
    v_mfma_f32_16x16x32_bf16 v[200:203], v[76:79], v[228:231], v[200:203]
    v_mfma_f32_16x16x32_bf16 v[204:207], v[92:95], v[228:231], v[204:207]
    v_mfma_f32_16x16x32_bf16 v[200:203], v[112:115], v[228:231], v[200:203]
    v_mfma_f32_16x16x32_bf16 v[204:207], v[128:131], v[228:231], v[204:207]
    s_branch K1_CS_1_6_e
K1_CS_1_6_2:
    s_cmp_lg_u32 s47, 2
    s_cbranch_scc1 K1_CS_1_6_3
    v_mfma_f32_16x16x32_bf16 v[200:203], v[80:83], v[228:231], v[200:203]
    v_mfma_f32_16x16x32_bf16 v[204:207], v[96:99], v[228:231], v[204:207]
    v_mfma_f32_16x16x32_bf16 v[200:203], v[116:119], v[228:231], v[200:203]
    v_mfma_f32_16x16x32_bf16 v[204:207], v[132:135], v[228:231], v[204:207]
    s_branch K1_CS_1_6_e
K1_CS_1_6_3:
    v_mfma_f32_16x16x32_bf16 v[200:203], v[84:87], v[228:231], v[200:203]
    v_mfma_f32_16x16x32_bf16 v[200:203], v[120:123], v[228:231], v[200:203]
K1_CS_1_6_e:
    v_mfma_f32_16x16x32_bf16 v[136:139], v[108:111], v[100:103], v[136:139]
    ds_read_b128 v[64:67], v16 offset:16384
    ds_read_b128 v[68:71], v18 offset:16384
    v_mfma_f32_16x16x32_bf16 v[140:143], v[108:111], v[104:107], v[140:143]
    ds_read_b64_tr_b16 v[72:73], v232 offset:16384
    ds_read_b64_tr_b16 v[74:75], v232 offset:17408
    v_mfma_f32_16x16x32_bf16 v[144:147], v[112:115], v[100:103], v[144:147]
    ds_read_b64_tr_b16 v[76:77], v233 offset:16384
    ds_read_b64_tr_b16 v[78:79], v233 offset:17408
    v_mfma_f32_16x16x32_bf16 v[148:151], v[112:115], v[104:107], v[148:151]
    ds_read_b64_tr_b16 v[80:81], v234 offset:16384
    ds_read_b64_tr_b16 v[82:83], v234 offset:17408
    v_mfma_f32_16x16x32_bf16 v[152:155], v[116:119], v[100:103], v[152:155]
    ds_read_b64_tr_b16 v[84:85], v235 offset:16384
    ds_read_b64_tr_b16 v[86:87], v235 offset:17408
    v_mfma_f32_16x16x32_bf16 v[156:159], v[116:119], v[104:107], v[156:159]
    ds_read_b64_tr_b16 v[88:89], v236 offset:16384
    ds_read_b64_tr_b16 v[90:91], v236 offset:17408
    v_mfma_f32_16x16x32_bf16 v[160:163], v[120:123], v[100:103], v[160:163]
    ds_read_b64_tr_b16 v[92:93], v237 offset:16384
    ds_read_b64_tr_b16 v[94:95], v237 offset:17408
    v_mfma_f32_16x16x32_bf16 v[164:167], v[120:123], v[104:107], v[164:167]
    ds_read_b64_tr_b16 v[96:97], v238 offset:16384
    ds_read_b64_tr_b16 v[98:99], v238 offset:17408
    v_mfma_f32_16x16x32_bf16 v[168:171], v[124:127], v[100:103], v[168:171]
    v_mfma_f32_16x16x32_bf16 v[172:175], v[124:127], v[104:107], v[172:175]
    v_mfma_f32_16x16x32_bf16 v[176:179], v[128:131], v[100:103], v[176:179]
    v_mfma_f32_16x16x32_bf16 v[180:183], v[128:131], v[104:107], v[180:183]
    v_mfma_f32_16x16x32_bf16 v[184:187], v[132:135], v[100:103], v[184:187]
    v_mfma_f32_16x16x32_bf16 v[188:191], v[132:135], v[104:107], v[188:191]
    v_mfma_f32_16x16x32_bf16 v[192:195], v[228:231], v[100:103], v[192:195]
    v_mfma_f32_16x16x32_bf16 v[196:199], v[100:103], v[100:103], v[196:199]
    s_waitcnt lgkmcnt(0)
    v_mfma_f32_16x16x32_bf16 v[136:139], v[72:75], v[64:67], v[136:139]
    ds_read_b128 v[100:103], v17 offset:16384
    ds_read_b128 v[104:107], v19 offset:16384
    v_mfma_f32_16x16x32_bf16 v[140:143], v[72:75], v[68:71], v[140:143]
    ds_read_b64_tr_b16 v[108:109], v232 offset:24576
    ds_read_b64_tr_b16 v[110:111], v232 offset:25600
    v_mfma_f32_16x16x32_bf16 v[144:147], v[76:79], v[64:67], v[144:147]
    ds_read_b64_tr_b16 v[112:113], v233 offset:24576
    ds_read_b64_tr_b16 v[114:115], v233 offset:25600
    v_mfma_f32_16x16x32_bf16 v[148:151], v[76:79], v[68:71], v[148:151]
    ds_read_b64_tr_b16 v[116:117], v234 offset:24576
    ds_read_b64_tr_b16 v[118:119], v234 offset:25600
    v_mfma_f32_16x16x32_bf16 v[152:155], v[80:83], v[64:67], v[152:155]
    ds_read_b64_tr_b16 v[120:121], v235 offset:24576
    ds_read_b64_tr_b16 v[122:123], v235 offset:25600
    v_mfma_f32_16x16x32_bf16 v[156:159], v[80:83], v[68:71], v[156:159]
    ds_read_b64_tr_b16 v[124:125], v236 offset:24576
    ds_read_b64_tr_b16 v[126:127], v236 offset:25600
    v_mfma_f32_16x16x32_bf16 v[160:163], v[84:87], v[64:67], v[160:163]
    ds_read_b64_tr_b16 v[128:129], v237 offset:24576
    ds_read_b64_tr_b16 v[130:131], v237 offset:25600
    v_mfma_f32_16x16x32_bf16 v[164:167], v[84:87], v[68:71], v[164:167]
    ds_read_b64_tr_b16 v[132:133], v238 offset:24576
    ds_read_b64_tr_b16 v[134:135], v238 offset:25600
    v_mfma_f32_16x16x32_bf16 v[168:171], v[88:91], v[64:67], v[168:171]
    v_mfma_f32_16x16x32_bf16 v[172:175], v[88:91], v[68:71], v[172:175]
    v_mfma_f32_16x16x32_bf16 v[176:179], v[92:95], v[64:67], v[176:179]
    v_mfma_f32_16x16x32_bf16 v[180:183], v[92:95], v[68:71], v[180:183]
    v_mfma_f32_16x16x32_bf16 v[184:187], v[96:99], v[64:67], v[184:187]
    v_mfma_f32_16x16x32_bf16 v[188:191], v[96:99], v[68:71], v[188:191]
    v_mfma_f32_16x16x32_bf16 v[192:195], v[228:231], v[64:67], v[192:195]
    v_mfma_f32_16x16x32_bf16 v[196:199], v[64:67], v[64:67], v[196:199]
    s_waitcnt lgkmcnt(0)
    s_barrier
    v_and_b32 v4, 3, v2
    v_lshrrev_b32 v5, 2, v2
    v_cmp_eq_u32 s[40:41], 1, v4
    v_cmp_eq_u32 s[50:51], 2, v4
    v_cmp_eq_u32 s[56:57], 3, v4
    v_cmp_eq_u32 s[58:59], v5, v3
    v_cmp_eq_u32 s[60:61], 0, v2

    s_cmp_lg_u32 s47, 0
    s_cbranch_scc1 K1_CS_1_7_1
    v_mfma_f32_16x16x32_bf16 v[200:203], v[72:75], v[228:231], v[200:203]
    v_mfma_f32_16x16x32_bf16 v[204:207], v[88:91], v[228:231], v[204:207]
    v_mfma_f32_16x16x32_bf16 v[200:203], v[108:111], v[228:231], v[200:203]
    v_mfma_f32_16x16x32_bf16 v[204:207], v[124:127], v[228:231], v[204:207]
    s_branch K1_CS_1_7_e
K1_CS_1_7_1:
    s_cmp_lg_u32 s47, 1
    s_cbranch_scc1 K1_CS_1_7_2
    v_mfma_f32_16x16x32_bf16 v[200:203], v[76:79], v[228:231], v[200:203]
    v_mfma_f32_16x16x32_bf16 v[204:207], v[92:95], v[228:231], v[204:207]
    v_mfma_f32_16x16x32_bf16 v[200:203], v[112:115], v[228:231], v[200:203]
    v_mfma_f32_16x16x32_bf16 v[204:207], v[128:131], v[228:231], v[204:207]
    s_branch K1_CS_1_7_e
K1_CS_1_7_2:
    s_cmp_lg_u32 s47, 2
    s_cbranch_scc1 K1_CS_1_7_3
    v_mfma_f32_16x16x32_bf16 v[200:203], v[80:83], v[228:231], v[200:203]
    v_mfma_f32_16x16x32_bf16 v[204:207], v[96:99], v[228:231], v[204:207]
    v_mfma_f32_16x16x32_bf16 v[200:203], v[116:119], v[228:231], v[200:203]
    v_mfma_f32_16x16x32_bf16 v[204:207], v[132:135], v[228:231], v[204:207]
    s_branch K1_CS_1_7_e
K1_CS_1_7_3:
    v_mfma_f32_16x16x32_bf16 v[200:203], v[84:87], v[228:231], v[200:203]
    v_mfma_f32_16x16x32_bf16 v[200:203], v[120:123], v[228:231], v[200:203]
K1_CS_1_7_e:
    v_mfma_f32_16x16x32_bf16 v[192:195], v[228:231], v[100:103], v[192:195]
    v_mfma_f32_16x16x32_bf16 v[196:199], v[100:103], v[100:103], v[196:199]
    v_mfma_f32_16x16x32_bf16 v[136:139], v[108:111], v[100:103], v[136:139]
    v_mfma_f32_16x16x32_bf16 v[140:143], v[108:111], v[104:107], v[140:143]
    v_mfma_f32_16x16x32_bf16 v[144:147], v[112:115], v[100:103], v[144:147]
    v_mfma_f32_16x16x32_bf16 v[148:151], v[112:115], v[104:107], v[148:151]
    v_mfma_f32_16x16x32_bf16 v[152:155], v[116:119], v[100:103], v[152:155]
    v_mfma_f32_16x16x32_bf16 v[156:159], v[116:119], v[104:107], v[156:159]
    s_mov_b64 exec, s[60:61]
    ds_write_b128 v34, v[200:203]
    ds_write_b128 v34, v[204:207] offset:256
    s_mov_b64 exec, -1

    v_mfma_f32_16x16x32_bf16 v[160:163], v[120:123], v[100:103], v[160:163]
    v_mfma_f32_16x16x32_bf16 v[164:167], v[120:123], v[104:107], v[164:167]
    v_cndmask_b32 v7, v196, v197, s[40:41]
    v_cndmask_b32 v7, v7, v198, s[50:51]
    v_cndmask_b32 v7, v7, v199, s[56:57]
    v_mov_b32 v6, v192
    s_mov_b64 exec, s[58:59]
    ds_write_b64 v33, v[6:7]
    s_mov_b64 exec, -1
    ds_read_b64_tr_b16 v[56:57], v38
    ds_read_b64_tr_b16 v[58:59], v38 offset:512
    s_nop 1

    v_mfma_f32_16x16x32_bf16 v[168:171], v[124:127], v[100:103], v[168:171]
    v_mfma_f32_16x16x32_bf16 v[172:175], v[124:127], v[104:107], v[172:175]
    v_mfma_f32_16x16x32_bf16 v[176:179], v[128:131], v[100:103], v[176:179]
    v_mfma_f32_16x16x32_bf16 v[180:183], v[128:131], v[104:107], v[180:183]
    v_mfma_f32_16x16x32_bf16 v[184:187], v[132:135], v[100:103], v[184:187]
    v_mfma_f32_16x16x32_bf16 v[188:191], v[132:135], v[104:107], v[188:191]
    s_waitcnt lgkmcnt(0)
    s_barrier

    ds_read_b64 v[4:5], v33
    ds_read_b64 v[6:7], v35

    ds_read_b128 v[64:67], v36 offset:0
    ds_read_b128 v[68:71], v36 offset:64
    ds_read_b128 v[72:75], v36 offset:128
    ds_read_b128 v[76:79], v36 offset:192
    ds_read_b128 v[80:83], v36 offset:256
    ds_read_b128 v[84:87], v36 offset:320
    ds_read_b128 v[88:91], v36 offset:384
    s_waitcnt lgkmcnt(7)
    v_mul_f32 v4, 0x3b000000, v4
    v_mul_f32 v5, 0x3b000000, v5
    v_mul_f32 v6, 0x3b000000, v6
    v_mul_f32 v7, 0x3b000000, v7
    v_fma_f32 v5, -v4, v4, v5
    v_fma_f32 v7, -v6, v6, v7
    v_max_f32 v5, 0, v5
    v_max_f32 v7, 0, v7
    v_add_f32 v5, 0x3727c5ac, v5
    v_add_f32 v7, 0x3727c5ac, v7
    v_rsq_f32 v60, v5
    v_rsq_f32 v61, v7
    v_sub_f32 v20, 0, v4
    v_sub_f32 v21, 0, v6
    v_mul_f32 v62, v20, v60
    v_mul_f32 v63, v21, v61
    v_mul_f32 v22, s55, v60
    v_mul_f32 v23, s55, v61
    s_waitcnt lgkmcnt(0)

    s_lshl_b32 s50, s42, 5
    s_lshl_b32 s51, s45, 1
    s_add_u32 s50, s50, s51
    s_lshl_b32 s50, s50, 10
    s_add_u32 s60, s50, 8388608
    s_add_u32 s61, s60, 32768
    s_lshl_b32 s50, s47, 10
    s_add_u32 s50, s50, 24576
    v_lshlrev_b32 v39, 3, v1
    v_add_u32 v39, s50, v39

    v_lshlrev_b32 v100, 16, v40
    v_and_b32 v101, 0xffff0000, v40
    v_lshlrev_b32 v102, 16, v41
    v_and_b32 v103, 0xffff0000, v41

    v_lshlrev_b32 v104, 16, v42
    v_and_b32 v105, 0xffff0000, v42
    v_lshlrev_b32 v106, 16, v43
    v_and_b32 v107, 0xffff0000, v43

    v_lshlrev_b32 v108, 16, v44
    v_and_b32 v109, 0xffff0000, v44
    v_lshlrev_b32 v110, 16, v45
    v_and_b32 v111, 0xffff0000, v45

    v_lshlrev_b32 v112, 16, v46
    v_and_b32 v113, 0xffff0000, v46
    v_lshlrev_b32 v114, 16, v47
    v_and_b32 v115, 0xffff0000, v47

    v_lshlrev_b32 v116, 16, v48
    v_and_b32 v117, 0xffff0000, v48
    v_lshlrev_b32 v118, 16, v49
    v_and_b32 v119, 0xffff0000, v49

    v_lshlrev_b32 v120, 16, v50
    v_and_b32 v121, 0xffff0000, v50
    v_lshlrev_b32 v122, 16, v51
    v_and_b32 v123, 0xffff0000, v51

    v_lshlrev_b32 v124, 16, v52
    v_and_b32 v125, 0xffff0000, v52
    v_lshlrev_b32 v126, 16, v53
    v_and_b32 v127, 0xffff0000, v53

    s_lshr_b32 s50, s45, 1
    s_mul_i32 s50, s50, 7
    s_lshl_b32 s51, s43, 2
    s_add_u32 s51, s51, s50
    s_add_u32 s50, s50, 3
    s_lshl_b32 s51, s51, 10
    s_lshl_b32 s50, s50, 10
    s_lshl_b32 s52, s43, 3
    s_add_u32 s50, s50, s52
    s_mul_i32 s53, s42, 57344
    s_add_u32 s52, s53, 57344
    s_add_u32 s56, s51, s52
    s_add_u32 s57, s51, s53
    s_add_u32 s58, s50, s52
    s_add_u32 s59, s50, s53

    v_fma_f32 v128, v62, v64, v100
    v_fma_f32 v129, v62, v65, v101
    v_fma_f32 v130, v62, v66, v102
    v_fma_f32 v131, v62, v67, v103
    v_fma_f32 v136, v136, v60, v128
    v_fma_f32 v137, v137, v60, v129
    v_fma_f32 v138, v138, v60, v130
    v_fma_f32 v139, v139, v60, v131
    v_max_f32 v136, 0, v136
    v_max_f32 v137, 0, v137
    v_max_f32 v138, 0, v138
    v_max_f32 v139, 0, v139
    v_mul_f32 v136, v136, v136
    v_mul_f32 v137, v137, v137
    v_mul_f32 v138, v138, v138
    v_mul_f32 v139, v139, v139
    v_cvt_pk_bf16_f32 v192, v136, v137
    v_cvt_pk_bf16_f32 v193, v138, v139
    v_fma_f32 v132, v62, v68, v104
    v_fma_f32 v133, v62, v69, v105
    v_fma_f32 v134, v62, v70, v106
    v_fma_f32 v135, v62, v71, v107
    v_fma_f32 v144, v144, v60, v132
    v_fma_f32 v145, v145, v60, v133
    v_fma_f32 v146, v146, v60, v134
    v_fma_f32 v147, v147, v60, v135
    v_max_f32 v144, 0, v144
    v_max_f32 v145, 0, v145
    v_max_f32 v146, 0, v146
    v_max_f32 v147, 0, v147
    v_mul_f32 v144, v144, v144
    v_mul_f32 v145, v145, v145
    v_mul_f32 v146, v146, v146
    v_mul_f32 v147, v147, v147
    v_cvt_pk_bf16_f32 v194, v144, v145
    v_cvt_pk_bf16_f32 v195, v146, v147
    buffer_store_dwordx4 v[192:195], v37, s[32:35], s56 offen offset:0 sc0 sc1
    v_fma_f32 v128, v62, v72, v108
    v_fma_f32 v129, v62, v73, v109
    v_fma_f32 v130, v62, v74, v110
    v_fma_f32 v131, v62, v75, v111
    v_fma_f32 v152, v152, v60, v128
    v_fma_f32 v153, v153, v60, v129
    v_fma_f32 v154, v154, v60, v130
    v_fma_f32 v155, v155, v60, v131
    v_max_f32 v152, 0, v152
    v_max_f32 v153, 0, v153
    v_max_f32 v154, 0, v154
    v_max_f32 v155, 0, v155
    v_mul_f32 v152, v152, v152
    v_mul_f32 v153, v153, v153
    v_mul_f32 v154, v154, v154
    v_mul_f32 v155, v155, v155
    v_cvt_pk_bf16_f32 v196, v152, v153
    v_cvt_pk_bf16_f32 v197, v154, v155
    v_fma_f32 v132, v62, v76, v112
    v_fma_f32 v133, v62, v77, v113
    v_fma_f32 v134, v62, v78, v114
    v_fma_f32 v135, v62, v79, v115
    v_fma_f32 v160, v160, v60, v132
    v_fma_f32 v161, v161, v60, v133
    v_fma_f32 v162, v162, v60, v134
    v_fma_f32 v163, v163, v60, v135
    v_max_f32 v160, 0, v160
    v_max_f32 v161, 0, v161
    v_max_f32 v162, 0, v162
    v_max_f32 v163, 0, v163
    v_mul_f32 v160, v160, v160
    v_mul_f32 v161, v161, v161
    v_mul_f32 v162, v162, v162
    v_mul_f32 v163, v163, v163
    v_cvt_pk_bf16_f32 v198, v160, v161
    v_cvt_pk_bf16_f32 v199, v162, v163
    buffer_store_dwordx4 v[196:199], v37, s[32:35], s56 offen offset:1024 sc0 sc1
    v_fma_f32 v128, v62, v80, v116
    v_fma_f32 v129, v62, v81, v117
    v_fma_f32 v130, v62, v82, v118
    v_fma_f32 v131, v62, v83, v119
    v_fma_f32 v168, v168, v60, v128
    v_fma_f32 v169, v169, v60, v129
    v_fma_f32 v170, v170, v60, v130
    v_fma_f32 v171, v171, v60, v131
    v_max_f32 v168, 0, v168
    v_max_f32 v169, 0, v169
    v_max_f32 v170, 0, v170
    v_max_f32 v171, 0, v171
    v_mul_f32 v168, v168, v168
    v_mul_f32 v169, v169, v169
    v_mul_f32 v170, v170, v170
    v_mul_f32 v171, v171, v171
    v_cvt_pk_bf16_f32 v200, v168, v169
    v_cvt_pk_bf16_f32 v201, v170, v171
    v_fma_f32 v132, v62, v84, v120
    v_fma_f32 v133, v62, v85, v121
    v_fma_f32 v134, v62, v86, v122
    v_fma_f32 v135, v62, v87, v123
    v_fma_f32 v176, v176, v60, v132
    v_fma_f32 v177, v177, v60, v133
    v_fma_f32 v178, v178, v60, v134
    v_fma_f32 v179, v179, v60, v135
    v_max_f32 v176, 0, v176
    v_max_f32 v177, 0, v177
    v_max_f32 v178, 0, v178
    v_max_f32 v179, 0, v179
    v_mul_f32 v176, v176, v176
    v_mul_f32 v177, v177, v177
    v_mul_f32 v178, v178, v178
    v_mul_f32 v179, v179, v179
    v_cvt_pk_bf16_f32 v202, v176, v177
    v_cvt_pk_bf16_f32 v203, v178, v179
    buffer_store_dwordx4 v[200:203], v37, s[32:35], s56 offen offset:2048 sc0 sc1
    v_fma_f32 v128, v62, v88, v124
    v_fma_f32 v129, v62, v89, v125
    v_fma_f32 v130, v62, v90, v126
    v_fma_f32 v131, v62, v91, v127
    v_fma_f32 v184, v184, v60, v128
    v_fma_f32 v185, v185, v60, v129
    v_fma_f32 v186, v186, v60, v130
    v_fma_f32 v187, v187, v60, v131
    v_max_f32 v184, 0, v184
    v_max_f32 v185, 0, v185
    v_max_f32 v186, 0, v186
    v_max_f32 v187, 0, v187
    v_mul_f32 v184, v184, v184
    v_mul_f32 v185, v185, v185
    v_mul_f32 v186, v186, v186
    v_mul_f32 v187, v187, v187
    v_cvt_pk_bf16_f32 v204, v184, v185
    v_cvt_pk_bf16_f32 v205, v186, v187
    buffer_store_dwordx2 v[204:205], v37, s[32:35], s58 offen sc0 sc1
    s_barrier
    ds_read_b64 v[24:25], v39
    ds_read_b64 v[26:27], v39 offset:512

    v_fma_f32 v128, v63, v64, v100
    v_fma_f32 v129, v63, v65, v101
    v_fma_f32 v130, v63, v66, v102
    v_fma_f32 v131, v63, v67, v103
    v_fma_f32 v140, v140, v61, v128
    v_fma_f32 v141, v141, v61, v129
    v_fma_f32 v142, v142, v61, v130
    v_fma_f32 v143, v143, v61, v131
    v_max_f32 v140, 0, v140
    v_max_f32 v141, 0, v141
    v_max_f32 v142, 0, v142
    v_max_f32 v143, 0, v143
    v_mul_f32 v140, v140, v140
    v_mul_f32 v141, v141, v141
    v_mul_f32 v142, v142, v142
    v_mul_f32 v143, v143, v143
    v_cvt_pk_bf16_f32 v208, v140, v141
    v_cvt_pk_bf16_f32 v209, v142, v143
    v_fma_f32 v132, v63, v68, v104
    v_fma_f32 v133, v63, v69, v105
    v_fma_f32 v134, v63, v70, v106
    v_fma_f32 v135, v63, v71, v107
    v_fma_f32 v148, v148, v61, v132
    v_fma_f32 v149, v149, v61, v133
    v_fma_f32 v150, v150, v61, v134
    v_fma_f32 v151, v151, v61, v135
    v_max_f32 v148, 0, v148
    v_max_f32 v149, 0, v149
    v_max_f32 v150, 0, v150
    v_max_f32 v151, 0, v151
    v_mul_f32 v148, v148, v148
    v_mul_f32 v149, v149, v149
    v_mul_f32 v150, v150, v150
    v_mul_f32 v151, v151, v151
    v_cvt_pk_bf16_f32 v210, v148, v149
    v_cvt_pk_bf16_f32 v211, v150, v151
    buffer_store_dwordx4 v[208:211], v37, s[32:35], s57 offen offset:0 sc0 sc1
    v_fma_f32 v128, v63, v72, v108
    v_fma_f32 v129, v63, v73, v109
    v_fma_f32 v130, v63, v74, v110
    v_fma_f32 v131, v63, v75, v111
    v_fma_f32 v156, v156, v61, v128
    v_fma_f32 v157, v157, v61, v129
    v_fma_f32 v158, v158, v61, v130
    v_fma_f32 v159, v159, v61, v131
    v_max_f32 v156, 0, v156
    v_max_f32 v157, 0, v157
    v_max_f32 v158, 0, v158
    v_max_f32 v159, 0, v159
    v_mul_f32 v156, v156, v156
    v_mul_f32 v157, v157, v157
    v_mul_f32 v158, v158, v158
    v_mul_f32 v159, v159, v159
    v_cvt_pk_bf16_f32 v212, v156, v157
    v_cvt_pk_bf16_f32 v213, v158, v159
    v_fma_f32 v132, v63, v76, v112
    v_fma_f32 v133, v63, v77, v113
    v_fma_f32 v134, v63, v78, v114
    v_fma_f32 v135, v63, v79, v115
    v_fma_f32 v164, v164, v61, v132
    v_fma_f32 v165, v165, v61, v133
    v_fma_f32 v166, v166, v61, v134
    v_fma_f32 v167, v167, v61, v135
    v_max_f32 v164, 0, v164
    v_max_f32 v165, 0, v165
    v_max_f32 v166, 0, v166
    v_max_f32 v167, 0, v167
    v_mul_f32 v164, v164, v164
    v_mul_f32 v165, v165, v165
    v_mul_f32 v166, v166, v166
    v_mul_f32 v167, v167, v167
    v_cvt_pk_bf16_f32 v214, v164, v165
    v_cvt_pk_bf16_f32 v215, v166, v167
    buffer_store_dwordx4 v[212:215], v37, s[32:35], s57 offen offset:1024 sc0 sc1
    v_fma_f32 v128, v63, v80, v116
    v_fma_f32 v129, v63, v81, v117
    v_fma_f32 v130, v63, v82, v118
    v_fma_f32 v131, v63, v83, v119
    v_fma_f32 v172, v172, v61, v128
    v_fma_f32 v173, v173, v61, v129
    v_fma_f32 v174, v174, v61, v130
    v_fma_f32 v175, v175, v61, v131
    v_max_f32 v172, 0, v172
    v_max_f32 v173, 0, v173
    v_max_f32 v174, 0, v174
    v_max_f32 v175, 0, v175
    v_mul_f32 v172, v172, v172
    v_mul_f32 v173, v173, v173
    v_mul_f32 v174, v174, v174
    v_mul_f32 v175, v175, v175
    v_cvt_pk_bf16_f32 v216, v172, v173
    v_cvt_pk_bf16_f32 v217, v174, v175
    v_fma_f32 v132, v63, v84, v120
    v_fma_f32 v133, v63, v85, v121
    v_fma_f32 v134, v63, v86, v122
    v_fma_f32 v135, v63, v87, v123
    v_fma_f32 v180, v180, v61, v132
    v_fma_f32 v181, v181, v61, v133
    v_fma_f32 v182, v182, v61, v134
    v_fma_f32 v183, v183, v61, v135
    v_max_f32 v180, 0, v180
    v_max_f32 v181, 0, v181
    v_max_f32 v182, 0, v182
    v_max_f32 v183, 0, v183
    v_mul_f32 v180, v180, v180
    v_mul_f32 v181, v181, v181
    v_mul_f32 v182, v182, v182
    v_mul_f32 v183, v183, v183
    v_cvt_pk_bf16_f32 v218, v180, v181
    v_cvt_pk_bf16_f32 v219, v182, v183
    buffer_store_dwordx4 v[216:219], v37, s[32:35], s57 offen offset:2048 sc0 sc1
    v_fma_f32 v128, v63, v88, v124
    v_fma_f32 v129, v63, v89, v125
    v_fma_f32 v130, v63, v90, v126
    v_fma_f32 v131, v63, v91, v127
    v_fma_f32 v188, v188, v61, v128
    v_fma_f32 v189, v189, v61, v129
    v_fma_f32 v190, v190, v61, v130
    v_fma_f32 v191, v191, v61, v131
    v_max_f32 v188, 0, v188
    v_max_f32 v189, 0, v189
    v_max_f32 v190, 0, v190
    v_max_f32 v191, 0, v191
    v_mul_f32 v188, v188, v188
    v_mul_f32 v189, v189, v189
    v_mul_f32 v190, v190, v190
    v_mul_f32 v191, v191, v191
    v_cvt_pk_bf16_f32 v220, v188, v189
    v_cvt_pk_bf16_f32 v221, v190, v191
    buffer_store_dwordx2 v[220:221], v37, s[32:35], s59 offen sc0 sc1
    s_waitcnt lgkmcnt(0)
    v_mfma_f32_16x16x16_bf16 v[136:139], v[56:57], v[24:25], 0
    v_mfma_f32_16x16x16_bf16 v[140:143], v[58:59], v[26:27], 0
    s_lshr_b32 s50, s47, 1
    s_and_b32 s51, s47, 1
    v_lshrrev_b32 v4, 2, v2
    v_lshl_add_u32 v4, v3, 3, v4
    v_and_b32 v5, 3, v2
    v_lshlrev_b32 v5, 3, v5
    v_lshl_add_u32 v8, v4, 6, v5
    s_lshl_b32 s52, s50, 13
    s_lshl_b32 s53, s51, 5
    s_add_u32 s52, s52, s53
    s_add_u32 s52, s52, 0
    v_add_u32 v8, s52, v8
    v_lshl_add_u32 v9, v4, 5, v5
    s_lshl_b32 s52, s50, 12
    s_add_u32 s52, s52, 16384
    v_add_u32 v9, s52, v9
    s_lshl_b32 s52, s44, 5
    s_lshl_b32 s53, s45, 1
    s_add_u32 s53, s53, s50
    s_add_u32 s52, s52, s53
    s_lshl_b32 s51, s51, 4
    s_lshl_b32 s53, s52, 7
    s_add_u32 s53, s53, s51
    s_add_u32 s53, s53, 13631488
    s_lshl_b32 s52, s52, 11
    s_add_u32 s52, s52, s51
    s_add_u32 s52, s52, 12582912
    v_lshlrev_b32 v4, 5, v1
    v_lshlrev_b32 v5, 5, v3
    v_cmp_eq_u32 s[62:63], 0, v2

    v_max3_f32 v72, v136, v137, v138
    v_max3_f32 v84, v140, v141, v142
    v_max3_f32 v73, -v136, -v137, -v138
    v_max3_f32 v85, -v140, -v141, -v142
    v_max_f32 v72, v72, v139
    v_max_f32 v84, v84, v143
    v_max_f32_e64 v73, v73, -v139
    v_max_f32_e64 v85, v85, -v143
    s_nop 0
    v_permlane32_swap_b32 v72, v73
    v_permlane32_swap_b32 v84, v85
    v_max_f32 v74, v72, v73
    v_max_f32 v86, v84, v85
    v_mov_b32 v75, v74
    v_mov_b32 v87, v86
    s_nop 0
    v_permlane16_swap_b32 v74, v75
    v_permlane16_swap_b32 v86, v87
    v_max_f32 v72, v74, v75
    v_max_f32 v84, v86, v87
    v_mov_b32 v73, v72
    v_mov_b32 v85, v84
    s_nop 0
    v_permlane32_swap_b32 v72, v73
    v_permlane32_swap_b32 v84, v85
    v_mul_f32 v72, v22, v72
    v_mul_f32 v84, v22, v84
    v_mul_f32 v73, v22, v73
    v_mul_f32 v85, v22, v85
    v_fma_f32 v64, v136, v22, -v72
    v_fma_f32 v76, v140, v22, -v84
    v_fma_f32 v68, -v136, v22, -v73
    v_fma_f32 v80, -v140, v22, -v85
    v_fma_f32 v65, v137, v22, -v72
    v_fma_f32 v77, v141, v22, -v84
    v_fma_f32 v69, -v137, v22, -v73
    v_fma_f32 v81, -v141, v22, -v85
    v_fma_f32 v66, v138, v22, -v72
    v_fma_f32 v78, v142, v22, -v84
    v_fma_f32 v70, -v138, v22, -v73
    v_fma_f32 v82, -v142, v22, -v85
    v_fma_f32 v67, v139, v22, -v72
    v_fma_f32 v79, v143, v22, -v84
    v_fma_f32 v71, -v139, v22, -v73
    v_fma_f32 v83, -v143, v22, -v85
    v_exp_f32 v64, v64
    v_exp_f32 v76, v76
    v_exp_f32 v65, v65
    v_exp_f32 v77, v77
    v_exp_f32 v66, v66
    v_exp_f32 v78, v78
    v_exp_f32 v67, v67
    v_exp_f32 v79, v79
    v_exp_f32 v68, v68
    v_exp_f32 v80, v80
    v_exp_f32 v69, v69
    v_exp_f32 v81, v81
    v_exp_f32 v70, v70
    v_exp_f32 v82, v82
    v_exp_f32 v71, v71
    v_exp_f32 v83, v83
    v_add_f32 v72, v64, v65
    v_add_f32 v84, v76, v77
    v_add_f32 v73, v68, v69
    v_add_f32 v85, v80, v81
    v_add_f32 v74, v66, v67
    v_add_f32 v86, v78, v79
    v_add_f32 v75, v70, v71
    v_add_f32 v87, v82, v83
    v_add_f32 v72, v72, v74
    v_add_f32 v84, v84, v86
    v_add_f32 v73, v73, v75
    v_add_f32 v85, v85, v87
    s_nop 0
    v_permlane32_swap_b32 v72, v73
    v_permlane32_swap_b32 v84, v85
    v_add_f32 v74, v72, v73
    v_add_f32 v86, v84, v85
    v_mov_b32 v75, v74
    v_mov_b32 v87, v86
    s_nop 0
    v_permlane16_swap_b32 v74, v75
    v_permlane16_swap_b32 v86, v87
    v_add_f32 v72, v74, v75
    v_add_f32 v84, v86, v87
    v_mov_b32 v73, v72
    v_mov_b32 v85, v84
    s_nop 0
    v_permlane32_swap_b32 v72, v73
    v_permlane32_swap_b32 v84, v85
    v_rcp_f32 v72, v72
    v_rcp_f32 v84, v84
    v_rcp_f32 v73, v73
    v_rcp_f32 v85, v85
    v_mul_f32 v64, v64, v72
    v_mul_f32 v76, v76, v84
    v_mul_f32 v68, v68, v73
    v_mul_f32 v80, v80, v85
    v_mul_f32 v65, v65, v72
    v_mul_f32 v77, v77, v84
    v_mul_f32 v69, v69, v73
    v_mul_f32 v81, v81, v85
    v_mul_f32 v66, v66, v72
    v_mul_f32 v78, v78, v84
    v_mul_f32 v70, v70, v73
    v_mul_f32 v82, v82, v85
    v_mul_f32 v67, v67, v72
    v_mul_f32 v79, v79, v84
    v_mul_f32 v71, v71, v73
    v_mul_f32 v83, v83, v85
    v_cvt_pk_bf16_f32 v144, v64, v65
    v_cvt_pk_bf16_f32 v148, v76, v77
    v_cvt_pk_bf16_f32 v145, v66, v67
    v_cvt_pk_bf16_f32 v149, v78, v79
    v_cvt_pk_bf16_f32 v146, v68, v69
    v_cvt_pk_bf16_f32 v150, v80, v81
    v_cvt_pk_bf16_f32 v147, v70, v71
    v_cvt_pk_bf16_f32 v151, v82, v83
    buffer_store_dwordx4 v[144:147], v37, s[32:35], s61 offen offset:0 sc0 sc1
    buffer_store_dwordx4 v[148:151], v37, s[32:35], s61 offen offset:1024 sc0 sc1
    s_barrier
    ds_read_b64_tr_b16 v[152:153], v8 offset:0
    ds_read_b64_tr_b16 v[154:155], v8 offset:256
    ds_read_b64_tr_b16 v[156:157], v9 offset:0
    ds_read_b64_tr_b16 v[158:159], v9 offset:128

    ds_read_b64_tr_b16 v[160:161], v8 offset:2048
    ds_read_b64_tr_b16 v[162:163], v8 offset:2304
    ds_read_b64_tr_b16 v[164:165], v9 offset:1024
    ds_read_b64_tr_b16 v[166:167], v9 offset:1152

    ds_read_b64_tr_b16 v[168:169], v8 offset:4096
    ds_read_b64_tr_b16 v[170:171], v8 offset:4352
    ds_read_b64_tr_b16 v[172:173], v9 offset:2048
    ds_read_b64_tr_b16 v[174:175], v9 offset:2176

    ds_read_b64_tr_b16 v[176:177], v8 offset:6144
    ds_read_b64_tr_b16 v[178:179], v8 offset:6400
    ds_read_b64_tr_b16 v[180:181], v9 offset:3072
    ds_read_b64_tr_b16 v[182:183], v9 offset:3200

    s_waitcnt lgkmcnt(0)
    v_mfma_f32_16x16x32_bf16 v[44:47], v[152:155], v[156:159], 0
    v_mfma_f32_16x16x32_bf16 v[48:51], v[152:155], v[228:231], 0
    v_mfma_f32_16x16x32_bf16 v[44:47], v[160:163], v[164:167], v[44:47]
    v_mfma_f32_16x16x32_bf16 v[48:51], v[160:163], v[228:231], v[48:51]
    v_mfma_f32_16x16x32_bf16 v[44:47], v[168:171], v[172:175], v[44:47]
    v_mfma_f32_16x16x32_bf16 v[48:51], v[168:171], v[228:231], v[48:51]
    v_mfma_f32_16x16x32_bf16 v[44:47], v[176:179], v[180:183], v[44:47]
    v_mfma_f32_16x16x32_bf16 v[48:51], v[176:179], v[228:231], v[48:51]
    s_nop 6
    buffer_store_dwordx4 v[44:47], v4, s[32:35], s52 offen sc0 sc1
    s_mov_b64 exec, s[62:63]
    buffer_store_dwordx4 v[48:51], v5, s[32:35], s53 offen sc0 sc1
    s_mov_b64 exec, -1

    s_branch K1_END
K1_END:
    s_endpgm
.globl k2_kernel
.p2align 8
.type k2_kernel,@function
k2_kernel:
    s_cmp_ge_u32 s2, 256
    s_cbranch_scc1 K2_END
    s_load_dwordx2 s[4:5], s[0:1], 0
    s_load_dwordx2 s[6:7], s[0:1], 24
    s_load_dwordx4 s[8:11], s[0:1], 56
    s_load_dwordx2 s[12:13], s[0:1], 72
    s_load_dwordx2 s[16:17], s[0:1], 88

    v_lshrrev_b32 v4, 6, v0
    v_and_b32 v1, 63, v0
    v_and_b32 v2, 15, v0
    v_bfe_u32 v3, v0, 4, 2
    v_readfirstlane_b32 s46, v4
    s_and_b32 s50, s2, 7
    s_lshr_b32 s51, s2, 3
    s_lshl_b32 s52, s50, 2
    s_and_b32 s53, s51, 3
    s_add_u32 s60, s52, s53
    s_lshr_b32 s61, s51, 2
    s_mul_i32 s52, s53, 7
    s_mul_i32 s56, s61, 11
    s_add_u32 s52, s52, s56
    s_add_u32 s52, s52, s50
    s_mul_i32 s56, s52, 147
    s_lshr_b32 s56, s56, 12
    s_mul_i32 s56, s56, 28
    s_sub_u32 s42, s52, s56
    s_and_b32 s42, s42, 0
    s_lshl_b32 s52, s53, 1
    s_add_u32 s52, s52, s61
    s_add_u32 s52, s52, s50
    s_and_b32 s43, s52, 0
    s_and_b32 s47, s46, 3
    s_lshr_b32 s48, s46, 2
    s_lshl_b32 s54, s46, 10
    s_mov_b32 s55, 0x3fb8aa3b
    s_lshl_b32 s62, s60, 2
    s_add_u32 s62, s62, s47
    s_movk_i32 s58, 4096

    v_lshrrev_b32 v4, 3, v1
    s_lshl_b32 s50, s46, 3
    v_add_u32 v4, s50, v4
    v_and_b32 v5, 7, v1
    v_lshlrev_b32 v6, 1, v3
    v_xor_b32 v5, v5, v6
    v_lshlrev_b32 v5, 4, v5
    v_lshl_add_u32 v4, v4, 10, v5
    s_lshl_b32 s50, s61, 7
    v_add_u32 v10, s50, v4
    v_lshlrev_b32 v17, 4, v1
    s_mul_i32 s50, s62, 56
    s_add_u32 s50, s50, s48
    s_lshl_b32 s50, s50, 10
    v_add_u32 v11, s50, v17
    s_lshl_b32 s50, s62, 5
    s_lshl_b32 s51, s48, 1
    s_add_u32 s50, s50, s51
    s_lshl_b32 s50, s50, 10
    s_add_u32 s50, s50, 8388608
    v_add_u32 v12, s50, v17

    v_lshrrev_b32 v4, 2, v2
    v_lshl_add_u32 v4, v3, 2, v4
    s_lshl_b32 s50, s48, 5
    v_add_u32 v4, s50, v4
    v_lshrrev_b32 v5, 3, v2
    v_lshl_add_u32 v5, v3, 1, v5
    v_and_b32 v5, 3, v5
    v_lshlrev_b32 v5, 5, v5
    v_lshl_add_u32 v4, v4, 7, v5
    v_and_b32 v5, 3, v2
    v_lshl_add_u32 v13, v5, 3, v4
    v_xor_b32 v14, 32, v13
    v_xor_b32 v15, 64, v13
    v_xor_b32 v16, 96, v13
    v_add_u32 v236, 0x10000, v13
    v_add_u32 v237, 0x10000, v14
    v_add_u32 v238, 0x10000, v15
    v_add_u32 v239, 0x10000, v16

    s_lshl_b32 s50, s2, 3
    s_add_u32 s50, s50, s46
    s_sub_u32 s51, s50, 1024
    s_lshl_b32 s52, s50, 6
    s_add_u32 s52, s52, 12582912
    s_and_b32 s53, s51, 63
    s_lshl_b32 s53, s53, 6
    s_add_u32 s53, s53, 13631488
    s_cmp_lt_u32 s50, 1024
    s_cselect_b32 s52, s52, s53
    s_cselect_b32 s53, 16, 12
    v_lshrrev_b32 v4, 2, v1
    v_lshlrev_b32 v4, s53, v4
    v_and_b32 v5, 3, v1
    v_lshl_add_u32 v4, v5, 4, v4
    v_add_u32 v36, s52, v4
    s_lshl_b32 s52, s50, 5
    s_add_u32 s52, s52, 14680064
    v_lshlrev_b32 v5, 3, v5
    v_add_u32 v37, s52, v5
    s_lshl_b32 s50, s46, 12
    s_add_u32 s51, s50, 14680064
    v_add_u32 v38, s51, v17
    s_add_u32 s51, s50, 90112
    v_add_u32 v39, s51, v17
    s_lshl_b32 s50, s46, 8
    v_lshlrev_b32 v4, 2, v1
    v_add_u32 v4, s50, v4
    v_add_u32 v8, 14712832, v4
    v_add_u32 v9, 122880, v4
    s_lshl_b32 s50, s48, 11
    s_add_u32 s50, s50, 90112
    v_add_u32 v18, s50, v17
    s_lshl_b32 s50, s48, 7
    s_add_u32 s50, s50, 122880
    v_lshlrev_b32 v4, 4, v3
    v_add_u32 v19, s50, v4

    v_lshrrev_b32 v4, 3, v0
    v_and_b32 v5, 7, v0
    s_lshl_b32 s50, s60, 6
    v_add_u32 v6, s50, v4
    v_lshlrev_b32 v6, 10, v6
    v_lshlrev_b32 v7, 4, v5
    s_lshl_b32 s50, s61, 7
    v_add_u32 v7, s50, v7
    v_add_u32 v232, v6, v7
    v_mov_b32 v233, v7
    s_movk_i32 s50, 272
    v_mul_lo_u32 v6, v4, s50
    v_lshl_add_u32 v234, v5, 5, v6
    v_add_u32 v234, 24576, v234
    s_lshl_b32 s51, s47, 4
    v_add_u32 v6, s51, v2
    v_mul_lo_u32 v6, v6, s50
    v_lshl_add_u32 v6, v3, 4, v6
    s_mul_i32 s51, s48, 34816
    s_add_u32 s51, s51, 24576
    v_add_u32 v235, s51, v6

    v_mov_b32 v136, 0
    v_mov_b32 v137, 0
    v_mov_b32 v138, 0
    v_mov_b32 v139, 0
    v_mov_b32 v140, 0
    v_mov_b32 v141, 0
    v_mov_b32 v142, 0
    v_mov_b32 v143, 0
    v_mov_b32 v144, 0
    v_mov_b32 v145, 0
    v_mov_b32 v146, 0
    v_mov_b32 v147, 0
    v_mov_b32 v148, 0
    v_mov_b32 v149, 0
    v_mov_b32 v150, 0
    v_mov_b32 v151, 0
    v_mov_b32 v152, 0
    v_mov_b32 v153, 0
    v_mov_b32 v154, 0
    v_mov_b32 v155, 0
    v_mov_b32 v156, 0
    v_mov_b32 v157, 0
    v_mov_b32 v158, 0
    v_mov_b32 v159, 0
    v_mov_b32 v160, 0
    v_mov_b32 v161, 0
    v_mov_b32 v162, 0
    v_mov_b32 v163, 0
    v_mov_b32 v164, 0
    v_mov_b32 v165, 0
    v_mov_b32 v166, 0
    v_mov_b32 v167, 0
    s_waitcnt lgkmcnt(0)
    s_mov_b32 s20, s4
    s_and_b32 s21, s5, 0xffff
    s_mov_b32 s22, 2097152
    s_mov_b32 s23, 0x20000

    s_mov_b32 s24, s6
    s_and_b32 s25, s7, 0xffff
    s_mov_b32 s26, 524288
    s_mov_b32 s27, 0x20000

    s_mov_b32 s28, s8
    s_and_b32 s29, s9, 0xffff
    s_mov_b32 s30, 1835008
    s_mov_b32 s31, 0x20000

    s_mov_b32 s32, s16
    s_and_b32 s33, s17, 0xffff
    s_mov_b32 s34, 16777216
    s_mov_b32 s35, 0x20000

    s_mov_b32 s36, s10
    s_and_b32 s37, s11, 0xffff
    s_mov_b32 s38, 1024
    s_mov_b32 s39, 0x20000

    s_mov_b32 s64, s12
    s_and_b32 s65, s13, 0xffff
    s_mov_b32 s66, 2097152
    s_mov_b32 s67, 0x20000

    buffer_load_dwordx4 v[20:23], v36, s[32:35], 0 offen
    s_mov_b32 s56, 0
    s_add_u32 m0, s54, 0
    s_nop 0
    buffer_load_dwordx4 v10, s[28:31], s56 offen lds
    s_mov_b32 s57, 0
    buffer_load_dwordx4 v[40:43], v11, s[32:35], s57 offen
    s_mov_b32 s56, 65536
    s_add_u32 m0, s54, 8192
    s_nop 0
    buffer_load_dwordx4 v10, s[28:31], s56 offen lds
    s_mov_b32 s57, 2048
    buffer_load_dwordx4 v[44:47], v11, s[32:35], s57 offen
    s_mov_b32 s56, 131072
    s_add_u32 m0, s54, 16384
    s_nop 0
    buffer_load_dwordx4 v10, s[28:31], s56 offen lds
    s_mov_b32 s57, 4096
    buffer_load_dwordx4 v[48:51], v11, s[32:35], s57 offen
    s_mov_b32 s56, 196608
    s_add_u32 m0, s54, 24576
    s_nop 0
    buffer_load_dwordx4 v10, s[28:31], s56 offen lds
    s_mov_b32 s57, 6144
    buffer_load_dwordx4 v[52:55], v11, s[32:35], s57 offen
    s_waitcnt vmcnt(8)
    v_add_f32_dpp v24, v20, v20 row_ror:8 row_mask:0xf bank_mask:0xf
    v_add_f32_dpp v25, v21, v21 row_ror:8 row_mask:0xf bank_mask:0xf
    v_add_f32_dpp v26, v22, v22 row_ror:8 row_mask:0xf bank_mask:0xf
    v_add_f32_dpp v27, v23, v23 row_ror:8 row_mask:0xf bank_mask:0xf
    v_add_f32_dpp v20, v24, v24 row_ror:4 row_mask:0xf bank_mask:0xf
    v_add_f32_dpp v21, v25, v25 row_ror:4 row_mask:0xf bank_mask:0xf
    v_add_f32_dpp v22, v26, v26 row_ror:4 row_mask:0xf bank_mask:0xf
    v_add_f32_dpp v23, v27, v27 row_ror:4 row_mask:0xf bank_mask:0xf
    v_mov_b32 v24, v20
    v_mov_b32 v25, v21
    v_mov_b32 v26, v22
    v_mov_b32 v27, v23
    v_permlane16_swap_b32 v20, v24
    v_permlane16_swap_b32 v21, v25
    v_permlane16_swap_b32 v22, v26
    v_permlane16_swap_b32 v23, v27
    v_add_f32 v20, v20, v24
    v_add_f32 v21, v21, v25
    v_add_f32 v22, v22, v26
    v_add_f32 v23, v23, v27
    v_mov_b32 v24, v20
    v_mov_b32 v25, v21
    v_mov_b32 v26, v22
    v_mov_b32 v27, v23
    v_permlane32_swap_b32 v20, v24
    v_permlane32_swap_b32 v21, v25
    v_permlane32_swap_b32 v22, v26
    v_permlane32_swap_b32 v23, v27
    v_add_f32 v20, v20, v24
    v_add_f32 v21, v21, v25
    v_add_f32 v22, v22, v26
    v_add_f32 v23, v23, v27
    v_cvt_pk_bf16_f32 v24, v20, v21
    v_cvt_pk_bf16_f32 v25, v22, v23
    v_min_u32 v24, 0xfffeffff, v24
    v_min_u32 v25, 0xfffeffff, v25
    s_mov_b64 exec, 15
    buffer_store_dwordx2 v[24:25], v37, s[32:35], 0 offen sc0 sc1
    s_mov_b64 exec, -1

    s_waitcnt vmcnt(6)
    s_barrier
    ds_read_b64_tr_b16 v[88:89], v13 offset:0
    ds_read_b64_tr_b16 v[90:91], v13 offset:2048
    ds_read_b64_tr_b16 v[92:93], v14 offset:0
    ds_read_b64_tr_b16 v[94:95], v14 offset:2048
    ds_read_b64_tr_b16 v[96:97], v15 offset:0
    ds_read_b64_tr_b16 v[98:99], v15 offset:2048
    ds_read_b64_tr_b16 v[100:101], v16 offset:0
    ds_read_b64_tr_b16 v[102:103], v16 offset:2048
    ds_read_b64_tr_b16 v[104:105], v13 offset:8192
    ds_read_b64_tr_b16 v[106:107], v13 offset:10240
    ds_read_b64_tr_b16 v[108:109], v14 offset:8192
    ds_read_b64_tr_b16 v[110:111], v14 offset:10240
    ds_read_b64_tr_b16 v[112:113], v15 offset:8192
    ds_read_b64_tr_b16 v[114:115], v15 offset:10240
    ds_read_b64_tr_b16 v[116:117], v16 offset:8192
    ds_read_b64_tr_b16 v[118:119], v16 offset:10240
    s_waitcnt vmcnt(2) lgkmcnt(8)
    s_barrier
    v_mfma_f32_16x16x32_bf16 v[136:139], v[88:91], v[40:43], v[136:139]
    ds_read_b64_tr_b16 v[120:121], v13 offset:16384
    ds_read_b64_tr_b16 v[122:123], v13 offset:18432
    ds_read_b64_tr_b16 v[124:125], v14 offset:16384
    ds_read_b64_tr_b16 v[126:127], v14 offset:18432
    v_mfma_f32_16x16x32_bf16 v[140:143], v[92:95], v[40:43], v[140:143]
    ds_read_b64_tr_b16 v[128:129], v15 offset:16384
    ds_read_b64_tr_b16 v[130:131], v15 offset:18432
    ds_read_b64_tr_b16 v[132:133], v16 offset:16384
    v_mfma_f32_16x16x32_bf16 v[144:147], v[96:99], v[40:43], v[144:147]
    ds_read_b64_tr_b16 v[134:135], v16 offset:18432
    s_mov_b32 s56, 262144
    s_add_u32 m0, s54, 32768
    s_nop 0
    buffer_load_dwordx4 v10, s[28:31], s56 offen lds
    s_mov_b32 s57, 8192
    buffer_load_dwordx4 v[56:59], v11, s[32:35], s57 offen
    s_mov_b32 s56, 327680
    s_add_u32 m0, s54, 40960
    s_nop 0
    buffer_load_dwordx4 v10, s[28:31], s56 offen lds
    v_mfma_f32_16x16x32_bf16 v[148:151], v[100:103], v[40:43], v[148:151]
    s_mov_b32 s57, 10240
    buffer_load_dwordx4 v[60:63], v11, s[32:35], s57 offen
    s_mov_b32 s56, 393216
    s_add_u32 m0, s54, 49152
    s_nop 0
    buffer_load_dwordx4 v10, s[28:31], s56 offen lds
    s_mov_b32 s57, 12288
    buffer_load_dwordx4 v[64:67], v11, s[32:35], s57 offen
    s_waitcnt lgkmcnt(8)
    v_mfma_f32_16x16x32_bf16 v[136:139], v[104:107], v[44:47], v[136:139]
    ds_read_b64_tr_b16 v[88:89], v13 offset:24576
    ds_read_b64_tr_b16 v[90:91], v13 offset:26624
    ds_read_b64_tr_b16 v[92:93], v14 offset:24576
    ds_read_b64_tr_b16 v[94:95], v14 offset:26624
    v_mfma_f32_16x16x32_bf16 v[140:143], v[108:111], v[44:47], v[140:143]
    ds_read_b64_tr_b16 v[96:97], v15 offset:24576
    ds_read_b64_tr_b16 v[98:99], v15 offset:26624
    ds_read_b64_tr_b16 v[100:101], v16 offset:24576
    v_mfma_f32_16x16x32_bf16 v[144:147], v[112:115], v[44:47], v[144:147]
    ds_read_b64_tr_b16 v[102:103], v16 offset:26624
    s_mov_b32 s56, 458752
    s_add_u32 m0, s54, 57344
    s_nop 0
    buffer_load_dwordx4 v10, s[28:31], s56 offen lds
    s_mov_b32 s57, 14336
    buffer_load_dwordx4 v[68:71], v11, s[32:35], s57 offen
    s_mov_b32 s56, 524288
    s_add_u32 m0, s54, 65536
    s_nop 0
    buffer_load_dwordx4 v10, s[28:31], s56 offen lds
    v_mfma_f32_16x16x32_bf16 v[148:151], v[116:119], v[44:47], v[148:151]
    s_mov_b32 s57, 16384
    buffer_load_dwordx4 v[72:75], v11, s[32:35], s57 offen
    s_mov_b32 s56, 589824
    s_add_u32 m0, s54, 73728
    s_nop 0
    buffer_load_dwordx4 v10, s[28:31], s56 offen lds
    s_mov_b32 s57, 18432
    buffer_load_dwordx4 v[76:79], v11, s[32:35], s57 offen
    s_waitcnt vmcnt(9) lgkmcnt(8)
    s_barrier
    v_mfma_f32_16x16x32_bf16 v[136:139], v[120:123], v[48:51], v[136:139]
    ds_read_b64_tr_b16 v[104:105], v13 offset:32768
    ds_read_b64_tr_b16 v[106:107], v13 offset:34816
    ds_read_b64_tr_b16 v[108:109], v14 offset:32768
    ds_read_b64_tr_b16 v[110:111], v14 offset:34816
    v_mfma_f32_16x16x32_bf16 v[140:143], v[124:127], v[48:51], v[140:143]
    ds_read_b64_tr_b16 v[112:113], v15 offset:32768
    ds_read_b64_tr_b16 v[114:115], v15 offset:34816
    ds_read_b64_tr_b16 v[116:117], v16 offset:32768
    v_mfma_f32_16x16x32_bf16 v[144:147], v[128:131], v[48:51], v[144:147]
    ds_read_b64_tr_b16 v[118:119], v16 offset:34816
    s_mov_b32 s56, 655360
    s_add_u32 m0, s54, 81920
    s_nop 0
    buffer_load_dwordx4 v10, s[28:31], s56 offen lds
    s_mov_b32 s57, 20480
    buffer_load_dwordx4 v[80:83], v11, s[32:35], s57 offen
    s_mov_b32 s56, 720896
    s_add_u32 m0, s54, 0
    s_nop 0
    buffer_load_dwordx4 v10, s[28:31], s56 offen lds
    v_mfma_f32_16x16x32_bf16 v[148:151], v[132:135], v[48:51], v[148:151]
    s_mov_b32 s57, 22528
    buffer_load_dwordx4 v[84:87], v11, s[32:35], s57 offen
    s_mov_b32 s56, 786432
    s_add_u32 m0, s54, 8192
    s_nop 0
    buffer_load_dwordx4 v10, s[28:31], s56 offen lds
    s_mov_b32 s57, 24576
    buffer_load_dwordx4 v[40:43], v11, s[32:35], s57 offen
    s_waitcnt lgkmcnt(8)
    v_mfma_f32_16x16x32_bf16 v[136:139], v[88:91], v[52:55], v[136:139]
    ds_read_b64_tr_b16 v[120:121], v13 offset:40960
    ds_read_b64_tr_b16 v[122:123], v13 offset:43008
    ds_read_b64_tr_b16 v[124:125], v14 offset:40960
    v_mfma_f32_16x16x32_bf16 v[140:143], v[92:95], v[52:55], v[140:143]
    ds_read_b64_tr_b16 v[126:127], v14 offset:43008
    ds_read_b64_tr_b16 v[128:129], v15 offset:40960
    ds_read_b64_tr_b16 v[130:131], v15 offset:43008
    v_mfma_f32_16x16x32_bf16 v[144:147], v[96:99], v[52:55], v[144:147]
    ds_read_b64_tr_b16 v[132:133], v16 offset:40960
    ds_read_b64_tr_b16 v[134:135], v16 offset:43008
    s_mov_b32 s56, 851968
    s_add_u32 m0, s54, 16384
    s_nop 0
    buffer_load_dwordx4 v10, s[28:31], s56 offen lds
    v_mfma_f32_16x16x32_bf16 v[148:151], v[100:103], v[52:55], v[148:151]
    s_mov_b32 s57, 26624
    buffer_load_dwordx4 v[44:47], v11, s[32:35], s57 offen
    s_mov_b32 s57, 28672
    buffer_load_dwordx4 v[48:51], v11, s[32:35], s57 offen
    s_waitcnt vmcnt(14) lgkmcnt(8)
    s_barrier
    v_mfma_f32_16x16x32_bf16 v[136:139], v[104:107], v[56:59], v[136:139]
    ds_read_b64_tr_b16 v[88:89], v13 offset:49152
    ds_read_b64_tr_b16 v[90:91], v13 offset:51200
    ds_read_b64_tr_b16 v[92:93], v14 offset:49152
    v_mfma_f32_16x16x32_bf16 v[140:143], v[108:111], v[56:59], v[140:143]
    ds_read_b64_tr_b16 v[94:95], v14 offset:51200
    ds_read_b64_tr_b16 v[96:97], v15 offset:49152
    ds_read_b64_tr_b16 v[98:99], v15 offset:51200
    v_mfma_f32_16x16x32_bf16 v[144:147], v[112:115], v[56:59], v[144:147]
    ds_read_b64_tr_b16 v[100:101], v16 offset:49152
    ds_read_b64_tr_b16 v[102:103], v16 offset:51200
    s_mov_b32 s56, 917504
    s_add_u32 m0, s54, 24576
    s_nop 0
    buffer_load_dwordx4 v10, s[28:31], s56 offen lds
    v_mfma_f32_16x16x32_bf16 v[148:151], v[116:119], v[56:59], v[148:151]
    s_mov_b32 s57, 30720
    buffer_load_dwordx4 v[52:55], v11, s[32:35], s57 offen
    s_mov_b32 s56, 983040
    s_add_u32 m0, s54, 32768
    s_nop 0
    buffer_load_dwordx4 v10, s[28:31], s56 offen lds
    s_waitcnt lgkmcnt(8)
    v_mfma_f32_16x16x32_bf16 v[136:139], v[120:123], v[60:63], v[136:139]
    ds_read_b64_tr_b16 v[104:105], v13 offset:57344
    ds_read_b64_tr_b16 v[106:107], v13 offset:59392
    ds_read_b64_tr_b16 v[108:109], v14 offset:57344
    v_mfma_f32_16x16x32_bf16 v[140:143], v[124:127], v[60:63], v[140:143]
    ds_read_b64_tr_b16 v[110:111], v14 offset:59392
    ds_read_b64_tr_b16 v[112:113], v15 offset:57344
    v_mfma_f32_16x16x32_bf16 v[144:147], v[128:131], v[60:63], v[144:147]
    ds_read_b64_tr_b16 v[114:115], v15 offset:59392
    ds_read_b64_tr_b16 v[116:117], v16 offset:57344
    v_mfma_f32_16x16x32_bf16 v[148:151], v[132:135], v[60:63], v[148:151]
    ds_read_b64_tr_b16 v[118:119], v16 offset:59392
    s_mov_b32 s57, 32768
    buffer_load_dwordx4 v[56:59], v11, s[32:35], s57 offen
    s_waitcnt vmcnt(14) lgkmcnt(8)
    s_barrier
    v_mfma_f32_16x16x32_bf16 v[136:139], v[88:91], v[64:67], v[136:139]
    ds_read_b64_tr_b16 v[120:121], v236 offset:0
    ds_read_b64_tr_b16 v[122:123], v236 offset:2048
    ds_read_b64_tr_b16 v[124:125], v237 offset:0
    ds_read_b64_tr_b16 v[126:127], v237 offset:2048
    v_mfma_f32_16x16x32_bf16 v[140:143], v[92:95], v[64:67], v[140:143]
    ds_read_b64_tr_b16 v[128:129], v238 offset:0
    ds_read_b64_tr_b16 v[130:131], v238 offset:2048
    ds_read_b64_tr_b16 v[132:133], v239 offset:0
    v_mfma_f32_16x16x32_bf16 v[144:147], v[96:99], v[64:67], v[144:147]
    ds_read_b64_tr_b16 v[134:135], v239 offset:2048
    buffer_load_dwordx4 v[28:31], v232, s[20:23], 0 offen
    buffer_load_dwordx4 v[32:35], v233, s[36:39], 0 offen
    v_mfma_f32_16x16x32_bf16 v[148:151], v[100:103], v[64:67], v[148:151]
    s_mov_b32 s56, 1048576
    s_add_u32 m0, s54, 40960
    s_nop 0
    buffer_load_dwordx4 v10, s[28:31], s56 offen lds
    s_mov_b32 s57, 34816
    buffer_load_dwordx4 v[60:63], v11, s[32:35], s57 offen
    s_mov_b32 s56, 1114112
    s_add_u32 m0, s54, 49152
    s_nop 0
    buffer_load_dwordx4 v10, s[28:31], s56 offen lds
    s_waitcnt lgkmcnt(8)
    v_mfma_f32_16x16x32_bf16 v[136:139], v[104:107], v[68:71], v[136:139]
    ds_read_b64_tr_b16 v[88:89], v236 offset:8192
    ds_read_b64_tr_b16 v[90:91], v236 offset:10240
    ds_read_b64_tr_b16 v[92:93], v237 offset:8192
    ds_read_b64_tr_b16 v[94:95], v237 offset:10240
    v_mfma_f32_16x16x32_bf16 v[140:143], v[108:111], v[68:71], v[140:143]
    ds_read_b64_tr_b16 v[96:97], v238 offset:8192
    ds_read_b64_tr_b16 v[98:99], v238 offset:10240
    ds_read_b64_tr_b16 v[100:101], v239 offset:8192
    v_mfma_f32_16x16x32_bf16 v[144:147], v[112:115], v[68:71], v[144:147]
    ds_read_b64_tr_b16 v[102:103], v239 offset:10240
    buffer_load_dwordx4 v[168:171], v38, s[32:35], 0 offen offset:0 sc1
    buffer_load_dwordx4 v[172:175], v38, s[32:35], 0 offen offset:1024 sc1
    buffer_load_dwordx4 v[176:179], v38, s[32:35], 0 offen offset:2048 sc1
    v_mfma_f32_16x16x32_bf16 v[148:151], v[116:119], v[68:71], v[148:151]
    buffer_load_dwordx4 v[180:183], v38, s[32:35], 0 offen offset:3072 sc1
    buffer_load_dword v184, v8, s[32:35], 0 offen sc1
    s_mov_b32 s57, 36864
    buffer_load_dwordx4 v[64:67], v11, s[32:35], s57 offen
    s_waitcnt vmcnt(21) lgkmcnt(8)
    s_barrier
    v_mfma_f32_16x16x32_bf16 v[136:139], v[120:123], v[72:75], v[136:139]
    ds_read_b64_tr_b16 v[104:105], v236 offset:16384
    ds_read_b64_tr_b16 v[106:107], v236 offset:18432
    ds_read_b64_tr_b16 v[108:109], v237 offset:16384
    v_mfma_f32_16x16x32_bf16 v[140:143], v[124:127], v[72:75], v[140:143]
    ds_read_b64_tr_b16 v[110:111], v237 offset:18432
    ds_read_b64_tr_b16 v[112:113], v238 offset:16384
    ds_read_b64_tr_b16 v[114:115], v238 offset:18432
    v_mfma_f32_16x16x32_bf16 v[144:147], v[128:131], v[72:75], v[144:147]
    ds_read_b64_tr_b16 v[116:117], v239 offset:16384
    ds_read_b64_tr_b16 v[118:119], v239 offset:18432
    s_mov_b32 s56, 1179648
    s_add_u32 m0, s54, 57344
    s_nop 0
    buffer_load_dwordx4 v10, s[28:31], s56 offen lds
    v_mfma_f32_16x16x32_bf16 v[148:151], v[132:135], v[72:75], v[148:151]
    s_mov_b32 s57, 38912
    buffer_load_dwordx4 v[68:71], v11, s[32:35], s57 offen
    s_mov_b32 s56, 1245184
    s_add_u32 m0, s54, 65536
    s_nop 0
    buffer_load_dwordx4 v10, s[28:31], s56 offen lds
    s_waitcnt lgkmcnt(8)
    v_mfma_f32_16x16x32_bf16 v[136:139], v[88:91], v[76:79], v[136:139]
    ds_read_b64_tr_b16 v[120:121], v13 offset:0
    ds_read_b64_tr_b16 v[122:123], v13 offset:2048
    ds_read_b64_tr_b16 v[124:125], v14 offset:0
    v_mfma_f32_16x16x32_bf16 v[140:143], v[92:95], v[76:79], v[140:143]
    ds_read_b64_tr_b16 v[126:127], v14 offset:2048
    ds_read_b64_tr_b16 v[128:129], v15 offset:0
    v_mfma_f32_16x16x32_bf16 v[144:147], v[96:99], v[76:79], v[144:147]
    ds_read_b64_tr_b16 v[130:131], v15 offset:2048
    ds_read_b64_tr_b16 v[132:133], v16 offset:0
    v_mfma_f32_16x16x32_bf16 v[148:151], v[100:103], v[76:79], v[148:151]
    ds_read_b64_tr_b16 v[134:135], v16 offset:2048
    s_mov_b32 s57, 0
    buffer_load_dwordx4 v[72:75], v12, s[32:35], s57 offen offset:0
    s_waitcnt vmcnt(21) lgkmcnt(8)
    s_barrier
    v_mfma_f32_16x16x32_bf16 v[136:139], v[104:107], v[80:83], v[136:139]
    ds_read_b64_tr_b16 v[88:89], v13 offset:8192
    ds_read_b64_tr_b16 v[90:91], v13 offset:10240
    ds_read_b64_tr_b16 v[92:93], v14 offset:8192
    v_mfma_f32_16x16x32_bf16 v[140:143], v[108:111], v[80:83], v[140:143]
    ds_read_b64_tr_b16 v[94:95], v14 offset:10240
    ds_read_b64_tr_b16 v[96:97], v15 offset:8192
    ds_read_b64_tr_b16 v[98:99], v15 offset:10240
    v_mfma_f32_16x16x32_bf16 v[144:147], v[112:115], v[80:83], v[144:147]
    ds_read_b64_tr_b16 v[100:101], v16 offset:8192
    ds_read_b64_tr_b16 v[102:103], v16 offset:10240
    s_mov_b32 s56, 0
    s_add_u32 m0, s54, 73728
    s_nop 0
    buffer_load_dwordx4 v10, s[24:27], s56 offen lds
    v_mfma_f32_16x16x32_bf16 v[148:151], v[116:119], v[80:83], v[148:151]
    s_mov_b32 s57, 0
    buffer_load_dwordx4 v[76:79], v12, s[32:35], s57 offen offset:1024
    s_mov_b32 s56, 65536
    s_add_u32 m0, s54, 81920
    s_nop 0
    buffer_load_dwordx4 v10, s[24:27], s56 offen lds
    s_waitcnt lgkmcnt(8)
    v_mfma_f32_16x16x32_bf16 v[136:139], v[120:123], v[84:87], v[136:139]
    ds_read_b64_tr_b16 v[104:105], v13 offset:16384
    ds_read_b64_tr_b16 v[106:107], v13 offset:18432
    ds_read_b64_tr_b16 v[108:109], v14 offset:16384
    v_mfma_f32_16x16x32_bf16 v[140:143], v[124:127], v[84:87], v[140:143]
    ds_read_b64_tr_b16 v[110:111], v14 offset:18432
    ds_read_b64_tr_b16 v[112:113], v15 offset:16384
    v_mfma_f32_16x16x32_bf16 v[144:147], v[128:131], v[84:87], v[144:147]
    ds_read_b64_tr_b16 v[114:115], v15 offset:18432
    ds_read_b64_tr_b16 v[116:117], v16 offset:16384
    v_mfma_f32_16x16x32_bf16 v[148:151], v[132:135], v[84:87], v[148:151]
    ds_read_b64_tr_b16 v[118:119], v16 offset:18432
    s_mov_b32 s57, 4096
    buffer_load_dwordx4 v[80:83], v12, s[32:35], s57 offen offset:0
    s_waitcnt vmcnt(20) lgkmcnt(8)
    s_barrier
    v_mfma_f32_16x16x32_bf16 v[136:139], v[88:91], v[40:43], v[136:139]
    ds_read_b64_tr_b16 v[120:121], v13 offset:24576
    ds_read_b64_tr_b16 v[122:123], v13 offset:26624
    ds_read_b64_tr_b16 v[124:125], v14 offset:24576
    v_mfma_f32_16x16x32_bf16 v[140:143], v[92:95], v[40:43], v[140:143]
    ds_read_b64_tr_b16 v[126:127], v14 offset:26624
    ds_read_b64_tr_b16 v[128:129], v15 offset:24576
    ds_read_b64_tr_b16 v[130:131], v15 offset:26624
    v_mfma_f32_16x16x32_bf16 v[144:147], v[96:99], v[40:43], v[144:147]
    ds_read_b64_tr_b16 v[132:133], v16 offset:24576
    ds_read_b64_tr_b16 v[134:135], v16 offset:26624
    s_mov_b32 s56, 131072
    s_add_u32 m0, s54, 0
    s_nop 0
    buffer_load_dwordx4 v10, s[24:27], s56 offen lds
    v_mfma_f32_16x16x32_bf16 v[148:151], v[100:103], v[40:43], v[148:151]
    s_mov_b32 s57, 4096
    buffer_load_dwordx4 v[84:87], v12, s[32:35], s57 offen offset:1024
    s_mov_b32 s56, 196608
    s_add_u32 m0, s54, 8192
    s_nop 0
    buffer_load_dwordx4 v10, s[24:27], s56 offen lds
    s_waitcnt lgkmcnt(8)
    v_mfma_f32_16x16x32_bf16 v[136:139], v[104:107], v[44:47], v[136:139]
    ds_read_b64_tr_b16 v[88:89], v13 offset:32768
    ds_read_b64_tr_b16 v[90:91], v13 offset:34816
    ds_read_b64_tr_b16 v[92:93], v14 offset:32768
    v_mfma_f32_16x16x32_bf16 v[140:143], v[108:111], v[44:47], v[140:143]
    ds_read_b64_tr_b16 v[94:95], v14 offset:34816
    ds_read_b64_tr_b16 v[96:97], v15 offset:32768
    v_mfma_f32_16x16x32_bf16 v[144:147], v[112:115], v[44:47], v[144:147]
    ds_read_b64_tr_b16 v[98:99], v15 offset:34816
    ds_read_b64_tr_b16 v[100:101], v16 offset:32768
    v_mfma_f32_16x16x32_bf16 v[148:151], v[116:119], v[44:47], v[148:151]
    ds_read_b64_tr_b16 v[102:103], v16 offset:34816
    s_mov_b32 s57, 8192
    buffer_load_dwordx4 v[40:43], v12, s[32:35], s57 offen offset:0
    s_waitcnt vmcnt(13) lgkmcnt(8)
    s_mov_b32 s49, 0
K2_KVCHK:
    v_max3_u32 v26, v168, v169, v184
    v_max3_u32 v26, v26, v170, v171
    v_max3_u32 v26, v26, v172, v173
    v_max3_u32 v26, v26, v174, v175
    v_max3_u32 v26, v26, v176, v177
    v_max3_u32 v26, v26, v178, v179
    v_max3_u32 v26, v26, v180, v181
    v_max3_u32 v26, v26, v182, v183
    v_cmp_eq_u32 vcc, -1, v26
    s_nop 4
    s_cbranch_vccz K2_KVOK
    s_add_u32 s49, s49, 1
    s_cmp_gt_u32 s49, 200
    s_cbranch_scc1 K2_KVSELF
    s_sleep 4

    buffer_load_dwordx4 v[168:171], v38, s[32:35], 0 offen offset:0 sc1
    buffer_load_dwordx4 v[172:175], v38, s[32:35], 0 offen offset:1024 sc1
    buffer_load_dwordx4 v[176:179], v38, s[32:35], 0 offen offset:2048 sc1
    buffer_load_dwordx4 v[180:183], v38, s[32:35], 0 offen offset:3072 sc1
    buffer_load_dword v184, v8, s[32:35], 0 offen sc1
    s_waitcnt vmcnt(0)
    s_branch K2_KVCHK
K2_KVSELF:

    s_lshl_b32 s50, s46, 13
    s_add_u32 s50, s50, 12582912
    v_lshlrev_b32 v26, 5, v1
    v_add_u32 v26, s50, v26

    v_mov_b32 v200, 0
    v_mov_b32 v201, 0
    v_mov_b32 v202, 0
    v_mov_b32 v203, 0
    v_mov_b32 v204, 0
    v_mov_b32 v205, 0
    v_mov_b32 v206, 0
    v_mov_b32 v207, 0
    s_mov_b32 s50, 0
K2_KVS_0:
    buffer_load_dwordx4 v[208:211], v26, s[32:35], s50 offen
    buffer_load_dwordx4 v[212:215], v26, s[32:35], s50 offen offset:16
    s_waitcnt vmcnt(0)

    v_add_f32 v200, v200, v208
    v_add_f32 v201, v201, v209
    v_add_f32 v202, v202, v210
    v_add_f32 v203, v203, v211
    v_add_f32 v204, v204, v212
    v_add_f32 v205, v205, v213
    v_add_f32 v206, v206, v214
    v_add_f32 v207, v207, v215
    s_add_u32 s50, s50, 65536
    s_cmp_lt_u32 s50, 1048576
    s_cbranch_scc1 K2_KVS_0

    v_cvt_pk_bf16_f32 v168, v200, v201
    v_cvt_pk_bf16_f32 v169, v202, v203
    v_cvt_pk_bf16_f32 v170, v204, v205
    v_cvt_pk_bf16_f32 v171, v206, v207
    v_mov_b32 v200, 0
    v_mov_b32 v201, 0
    v_mov_b32 v202, 0
    v_mov_b32 v203, 0
    v_mov_b32 v204, 0
    v_mov_b32 v205, 0
    v_mov_b32 v206, 0
    v_mov_b32 v207, 0
    s_mov_b32 s50, 2048
K2_KVS_1:
    buffer_load_dwordx4 v[208:211], v26, s[32:35], s50 offen
    buffer_load_dwordx4 v[212:215], v26, s[32:35], s50 offen offset:16
    s_waitcnt vmcnt(0)

    v_add_f32 v200, v200, v208
    v_add_f32 v201, v201, v209
    v_add_f32 v202, v202, v210
    v_add_f32 v203, v203, v211
    v_add_f32 v204, v204, v212
    v_add_f32 v205, v205, v213
    v_add_f32 v206, v206, v214
    v_add_f32 v207, v207, v215
    s_add_u32 s50, s50, 65536
    s_cmp_lt_u32 s50, 1048576
    s_cbranch_scc1 K2_KVS_1

    v_cvt_pk_bf16_f32 v172, v200, v201
    v_cvt_pk_bf16_f32 v173, v202, v203
    v_cvt_pk_bf16_f32 v174, v204, v205
    v_cvt_pk_bf16_f32 v175, v206, v207
    v_mov_b32 v200, 0
    v_mov_b32 v201, 0
    v_mov_b32 v202, 0
    v_mov_b32 v203, 0
    v_mov_b32 v204, 0
    v_mov_b32 v205, 0
    v_mov_b32 v206, 0
    v_mov_b32 v207, 0
    s_mov_b32 s50, 4096
K2_KVS_2:
    buffer_load_dwordx4 v[208:211], v26, s[32:35], s50 offen
    buffer_load_dwordx4 v[212:215], v26, s[32:35], s50 offen offset:16
    s_waitcnt vmcnt(0)

    v_add_f32 v200, v200, v208
    v_add_f32 v201, v201, v209
    v_add_f32 v202, v202, v210
    v_add_f32 v203, v203, v211
    v_add_f32 v204, v204, v212
    v_add_f32 v205, v205, v213
    v_add_f32 v206, v206, v214
    v_add_f32 v207, v207, v215
    s_add_u32 s50, s50, 65536
    s_cmp_lt_u32 s50, 1048576
    s_cbranch_scc1 K2_KVS_2

    v_cvt_pk_bf16_f32 v176, v200, v201
    v_cvt_pk_bf16_f32 v177, v202, v203
    v_cvt_pk_bf16_f32 v178, v204, v205
    v_cvt_pk_bf16_f32 v179, v206, v207
    v_mov_b32 v200, 0
    v_mov_b32 v201, 0
    v_mov_b32 v202, 0
    v_mov_b32 v203, 0
    v_mov_b32 v204, 0
    v_mov_b32 v205, 0
    v_mov_b32 v206, 0
    v_mov_b32 v207, 0
    s_mov_b32 s50, 6144
K2_KVS_3:
    buffer_load_dwordx4 v[208:211], v26, s[32:35], s50 offen
    buffer_load_dwordx4 v[212:215], v26, s[32:35], s50 offen offset:16
    s_waitcnt vmcnt(0)

    v_add_f32 v200, v200, v208
    v_add_f32 v201, v201, v209
    v_add_f32 v202, v202, v210
    v_add_f32 v203, v203, v211
    v_add_f32 v204, v204, v212
    v_add_f32 v205, v205, v213
    v_add_f32 v206, v206, v214
    v_add_f32 v207, v207, v215
    s_add_u32 s50, s50, 65536
    s_cmp_lt_u32 s50, 1048576
    s_cbranch_scc1 K2_KVS_3

    v_cvt_pk_bf16_f32 v180, v200, v201
    v_cvt_pk_bf16_f32 v181, v202, v203
    v_cvt_pk_bf16_f32 v182, v204, v205
    v_cvt_pk_bf16_f32 v183, v206, v207
    s_lshl_b32 s50, s46, 9
    s_add_u32 s50, s50, 13631488
    v_lshlrev_b32 v26, 3, v1
    v_add_u32 v26, s50, v26
    v_mov_b32 v200, 0
    v_mov_b32 v201, 0
    s_mov_b32 s50, 0
K2_KVS_Z:
    buffer_load_dwordx2 v[208:209], v26, s[32:35], s50 offen
    s_waitcnt vmcnt(0)
    v_add_f32 v200, v200, v208
    v_add_f32 v201, v201, v209
    s_add_u32 s50, s50, 4096
    s_cmp_lt_u32 s50, 65536
    s_cbranch_scc1 K2_KVS_Z
    v_cvt_pk_bf16_f32 v184, v200, v201

K2_KVOK:
    s_nop 1
    s_barrier
    v_mfma_f32_16x16x32_bf16 v[136:139], v[120:123], v[48:51], v[136:139]
    ds_read_b64_tr_b16 v[104:105], v13 offset:40960
    ds_read_b64_tr_b16 v[106:107], v13 offset:43008
    ds_read_b64_tr_b16 v[108:109], v14 offset:40960
    ds_read_b64_tr_b16 v[110:111], v14 offset:43008
    v_mfma_f32_16x16x32_bf16 v[140:143], v[124:127], v[48:51], v[140:143]
    ds_read_b64_tr_b16 v[112:113], v15 offset:40960
    ds_read_b64_tr_b16 v[114:115], v15 offset:43008
    ds_read_b64_tr_b16 v[116:117], v16 offset:40960
    v_mfma_f32_16x16x32_bf16 v[144:147], v[128:131], v[48:51], v[144:147]
    ds_read_b64_tr_b16 v[118:119], v16 offset:43008
    ds_write_b128 v39, v[168:171] offset:0
    ds_write_b128 v39, v[172:175] offset:1024
    ds_write_b32 v9, v184
    v_mfma_f32_16x16x32_bf16 v[148:151], v[132:135], v[48:51], v[148:151]
    s_mov_b32 s56, 262144
    s_add_u32 m0, s54, 16384
    s_nop 0
    buffer_load_dwordx4 v10, s[24:27], s56 offen lds
    s_mov_b32 s57, 8192
    buffer_load_dwordx4 v[44:47], v12, s[32:35], s57 offen offset:1024
    s_mov_b32 s56, 327680
    s_add_u32 m0, s54, 24576
    s_nop 0
    buffer_load_dwordx4 v10, s[24:27], s56 offen lds
    s_waitcnt lgkmcnt(11)
    v_mfma_f32_16x16x32_bf16 v[136:139], v[88:91], v[52:55], v[136:139]
    ds_read_b64_tr_b16 v[120:121], v13 offset:49152
    ds_read_b64_tr_b16 v[122:123], v13 offset:51200
    ds_read_b64_tr_b16 v[124:125], v14 offset:49152
    v_mfma_f32_16x16x32_bf16 v[140:143], v[92:95], v[52:55], v[140:143]
    ds_read_b64_tr_b16 v[126:127], v14 offset:51200
    ds_read_b64_tr_b16 v[128:129], v15 offset:49152
    ds_read_b64_tr_b16 v[130:131], v15 offset:51200
    v_mfma_f32_16x16x32_bf16 v[144:147], v[96:99], v[52:55], v[144:147]
    ds_read_b64_tr_b16 v[132:133], v16 offset:49152
    ds_read_b64_tr_b16 v[134:135], v16 offset:51200
    ds_write_b128 v39, v[176:179] offset:2048
    v_mfma_f32_16x16x32_bf16 v[148:151], v[100:103], v[52:55], v[148:151]
    ds_write_b128 v39, v[180:183] offset:3072
    s_mov_b32 s57, 12288
    buffer_load_dwordx4 v[48:51], v12, s[32:35], s57 offen offset:0
    s_waitcnt vmcnt(13) lgkmcnt(0)
    s_barrier
    v_mfma_f32_16x16x32_bf16 v[136:139], v[104:107], v[56:59], v[136:139]
    ds_read_b64_tr_b16 v[88:89], v13 offset:57344
    ds_read_b64_tr_b16 v[90:91], v13 offset:59392
    ds_read_b64_tr_b16 v[92:93], v14 offset:57344
    v_mfma_f32_16x16x32_bf16 v[140:143], v[108:111], v[56:59], v[140:143]
    ds_read_b64_tr_b16 v[94:95], v14 offset:59392
    ds_read_b64_tr_b16 v[96:97], v15 offset:57344
    ds_read_b64_tr_b16 v[98:99], v15 offset:59392
    v_mfma_f32_16x16x32_bf16 v[144:147], v[112:115], v[56:59], v[144:147]
    ds_read_b64_tr_b16 v[100:101], v16 offset:57344
    ds_read_b64_tr_b16 v[102:103], v16 offset:59392
    s_mov_b32 s56, 393216
    s_add_u32 m0, s54, 32768
    s_nop 0
    buffer_load_dwordx4 v10, s[24:27], s56 offen lds
    v_mfma_f32_16x16x32_bf16 v[148:151], v[116:119], v[56:59], v[148:151]
    s_mov_b32 s57, 12288
    buffer_load_dwordx4 v[52:55], v12, s[32:35], s57 offen offset:1024
    s_mov_b32 s56, 458752
    s_add_u32 m0, s54, 40960
    s_nop 0
    buffer_load_dwordx4 v10, s[24:27], s56 offen lds
    v_mfma_f32_16x16x32_bf16 v[136:139], v[120:123], v[60:63], v[136:139]
    ds_read_b64_tr_b16 v[104:105], v236 offset:0
    ds_read_b64_tr_b16 v[106:107], v236 offset:2048
    ds_read_b64_tr_b16 v[108:109], v237 offset:0
    v_mfma_f32_16x16x32_bf16 v[140:143], v[124:127], v[60:63], v[140:143]
    ds_read_b64_tr_b16 v[110:111], v237 offset:2048
    ds_read_b64_tr_b16 v[112:113], v238 offset:0
    v_mfma_f32_16x16x32_bf16 v[144:147], v[128:131], v[60:63], v[144:147]
    ds_read_b64_tr_b16 v[114:115], v238 offset:2048
    ds_read_b64_tr_b16 v[116:117], v239 offset:0
    v_mfma_f32_16x16x32_bf16 v[148:151], v[132:135], v[60:63], v[148:151]
    ds_read_b64_tr_b16 v[118:119], v239 offset:2048
    s_mov_b32 s57, 16384
    buffer_load_dwordx4 v[56:59], v12, s[32:35], s57 offen offset:0
    s_waitcnt vmcnt(13) lgkmcnt(8)
    s_barrier
    v_mfma_f32_16x16x32_bf16 v[136:139], v[88:91], v[64:67], v[136:139]
    ds_read_b64_tr_b16 v[120:121], v236 offset:8192
    ds_read_b64_tr_b16 v[122:123], v236 offset:10240
    ds_read_b64_tr_b16 v[124:125], v237 offset:8192
    ds_read_b64_tr_b16 v[126:127], v237 offset:10240
    v_mfma_f32_16x16x32_bf16 v[140:143], v[92:95], v[64:67], v[140:143]
    ds_read_b64_tr_b16 v[128:129], v238 offset:8192
    ds_read_b64_tr_b16 v[130:131], v238 offset:10240
    ds_read_b64_tr_b16 v[132:133], v239 offset:8192
    ds_read_b64_tr_b16 v[134:135], v239 offset:10240
    v_mfma_f32_16x16x32_bf16 v[144:147], v[96:99], v[64:67], v[144:147]
    ds_read_b128 v[240:243], v18 offset:0
    ds_read_b128 v[244:247], v19 offset:0
    ds_read_b128 v[248:251], v18 offset:1024
    ds_read_b128 v[252:255], v19 offset:64
    v_mfma_f32_16x16x32_bf16 v[148:151], v[100:103], v[64:67], v[148:151]
    s_mov_b32 s56, 1310720
    s_add_u32 m0, s54, 49152
    s_nop 0
    buffer_load_dwordx4 v10, s[28:31], s56 offen lds
    s_mov_b32 s57, 16384
    buffer_load_dwordx4 v[60:63], v12, s[32:35], s57 offen offset:1024
    s_mov_b32 s56, 1376256
    s_add_u32 m0, s54, 57344
    s_nop 0
    buffer_load_dwordx4 v10, s[28:31], s56 offen lds
    s_waitcnt lgkmcnt(12)
    v_mfma_f32_16x16x32_bf16 v[136:139], v[104:107], v[68:71], v[136:139]
    ds_read_b64_tr_b16 v[88:89], v236 offset:16384
    ds_read_b64_tr_b16 v[90:91], v236 offset:18432
    ds_read_b64_tr_b16 v[92:93], v237 offset:16384
    ds_read_b64_tr_b16 v[94:95], v237 offset:18432
    v_mfma_f32_16x16x32_bf16 v[140:143], v[108:111], v[68:71], v[140:143]
    ds_read_b64_tr_b16 v[96:97], v238 offset:16384
    ds_read_b64_tr_b16 v[98:99], v238 offset:18432
    ds_read_b64_tr_b16 v[100:101], v239 offset:16384
    v_mfma_f32_16x16x32_bf16 v[144:147], v[112:115], v[68:71], v[144:147]
    ds_read_b64_tr_b16 v[102:103], v239 offset:18432
    ds_read_b128 v[168:171], v18 offset:4096
    ds_read_b128 v[172:175], v19 offset:256
    v_mfma_f32_16x16x32_bf16 v[148:151], v[116:119], v[68:71], v[148:151]
    ds_read_b128 v[176:179], v18 offset:5120
    ds_read_b128 v[180:183], v19 offset:320
    s_mov_b32 s57, 20480
    buffer_load_dwordx4 v[64:67], v12, s[32:35], s57 offen offset:0
    s_waitcnt vmcnt(13) lgkmcnt(12)
    s_barrier
    v_mfma_f32_16x16x32_bf16 v[200:203], v[240:243], v[72:75], 0
    ds_read_b64_tr_b16 v[104:105], v13 offset:0
    ds_read_b64_tr_b16 v[106:107], v13 offset:2048
    ds_read_b64_tr_b16 v[108:109], v14 offset:0
    ds_read_b64_tr_b16 v[110:111], v14 offset:2048
    v_mfma_f32_16x16x32_bf16 v[204:207], v[244:247], v[72:75], 0
    ds_read_b64_tr_b16 v[112:113], v15 offset:0
    ds_read_b64_tr_b16 v[114:115], v15 offset:2048
    ds_read_b64_tr_b16 v[116:117], v16 offset:0
    ds_read_b64_tr_b16 v[118:119], v16 offset:2048
    v_mfma_f32_16x16x32_bf16 v[208:211], v[248:251], v[76:79], 0
    ds_read_b128 v[184:187], v18 offset:8192
    ds_read_b128 v[188:191], v19 offset:512
    ds_read_b128 v[192:195], v18 offset:9216
    ds_read_b128 v[196:199], v19 offset:576
    v_mfma_f32_16x16x32_bf16 v[212:215], v[252:255], v[76:79], 0
    s_mov_b32 s56, 1441792
    s_add_u32 m0, s54, 65536
    s_nop 0
    buffer_load_dwordx4 v10, s[28:31], s56 offen lds
    s_mov_b32 s57, 20480
    buffer_load_dwordx4 v[68:71], v12, s[32:35], s57 offen offset:1024
    s_mov_b32 s56, 1507328
    s_add_u32 m0, s54, 73728
    s_nop 0
    buffer_load_dwordx4 v10, s[28:31], s56 offen lds
    v_add_f32 v220, 0x358637bd, v204
    v_add_f32 v221, 0x358637bd, v212
    v_rcp_f32 v220, v220
    v_rcp_f32 v221, v221

    v_mul_f32 v200, v200, v220
    v_mul_f32 v201, v201, v220
    v_mul_f32 v202, v202, v220
    v_mul_f32 v203, v203, v220
    v_mul_f32 v208, v208, v221
    v_mul_f32 v209, v209, v221
    v_mul_f32 v210, v210, v221
    v_mul_f32 v211, v211, v221
    v_cvt_pk_bf16_f32 v216, v200, v201
    v_cvt_pk_bf16_f32 v217, v202, v203
    v_cvt_pk_bf16_f32 v218, v208, v209
    v_cvt_pk_bf16_f32 v219, v210, v211

    s_nop 1
    v_mfma_f32_16x16x32_bf16 v[152:155], v[120:123], v[216:219], v[152:155]
    v_mfma_f32_16x16x32_bf16 v[156:159], v[124:127], v[216:219], v[156:159]
    v_mfma_f32_16x16x32_bf16 v[160:163], v[128:131], v[216:219], v[160:163]
    v_mfma_f32_16x16x32_bf16 v[164:167], v[132:135], v[216:219], v[164:167]
    s_waitcnt lgkmcnt(12)
    v_mfma_f32_16x16x32_bf16 v[200:203], v[168:171], v[80:83], 0
    ds_read_b64_tr_b16 v[120:121], v13 offset:8192
    ds_read_b64_tr_b16 v[122:123], v13 offset:10240
    ds_read_b64_tr_b16 v[124:125], v14 offset:8192
    ds_read_b64_tr_b16 v[126:127], v14 offset:10240
    v_mfma_f32_16x16x32_bf16 v[204:207], v[172:175], v[80:83], 0
    ds_read_b64_tr_b16 v[128:129], v15 offset:8192
    ds_read_b64_tr_b16 v[130:131], v15 offset:10240
    ds_read_b64_tr_b16 v[132:133], v16 offset:8192
    v_mfma_f32_16x16x32_bf16 v[208:211], v[176:179], v[84:87], 0
    ds_read_b64_tr_b16 v[134:135], v16 offset:10240
    ds_read_b128 v[240:243], v18 offset:12288
    ds_read_b128 v[244:247], v19 offset:768
    ds_read_b128 v[248:251], v18 offset:13312
    v_mfma_f32_16x16x32_bf16 v[212:215], v[180:183], v[84:87], 0
    ds_read_b128 v[252:255], v19 offset:832
    s_mov_b32 s57, 24576
    buffer_load_dwordx4 v[72:75], v12, s[32:35], s57 offen offset:0
    s_mov_b32 s57, 24576
    buffer_load_dwordx4 v[76:79], v12, s[32:35], s57 offen offset:1024
    v_add_f32 v220, 0x358637bd, v204
    s_nop 1
    v_add_f32 v221, 0x358637bd, v212
    v_rcp_f32 v220, v220
    v_rcp_f32 v221, v221

    v_mul_f32 v200, v200, v220
    v_mul_f32 v201, v201, v220
    v_mul_f32 v202, v202, v220
    v_mul_f32 v203, v203, v220
    v_mul_f32 v208, v208, v221
    v_mul_f32 v209, v209, v221
    v_mul_f32 v210, v210, v221
    v_mul_f32 v211, v211, v221
    v_cvt_pk_bf16_f32 v216, v200, v201
    v_cvt_pk_bf16_f32 v217, v202, v203
    v_cvt_pk_bf16_f32 v218, v208, v209
    v_cvt_pk_bf16_f32 v219, v210, v211

    s_nop 1
    v_mfma_f32_16x16x32_bf16 v[152:155], v[88:91], v[216:219], v[152:155]
    v_mfma_f32_16x16x32_bf16 v[156:159], v[92:95], v[216:219], v[156:159]
    v_mfma_f32_16x16x32_bf16 v[160:163], v[96:99], v[216:219], v[160:163]
    v_mfma_f32_16x16x32_bf16 v[164:167], v[100:103], v[216:219], v[164:167]
    s_waitcnt vmcnt(14) lgkmcnt(12)
    s_barrier
    v_mfma_f32_16x16x32_bf16 v[200:203], v[184:187], v[40:43], 0
    ds_read_b64_tr_b16 v[88:89], v13 offset:16384
    ds_read_b64_tr_b16 v[90:91], v13 offset:18432
    ds_read_b64_tr_b16 v[92:93], v14 offset:16384
    ds_read_b64_tr_b16 v[94:95], v14 offset:18432
    v_mfma_f32_16x16x32_bf16 v[204:207], v[188:191], v[40:43], 0
    ds_read_b64_tr_b16 v[96:97], v15 offset:16384
    ds_read_b64_tr_b16 v[98:99], v15 offset:18432
    ds_read_b64_tr_b16 v[100:101], v16 offset:16384
    ds_read_b64_tr_b16 v[102:103], v16 offset:18432
    v_mfma_f32_16x16x32_bf16 v[208:211], v[192:195], v[44:47], 0
    ds_read_b128 v[168:171], v18 offset:16384
    ds_read_b128 v[172:175], v19 offset:1024
    ds_read_b128 v[176:179], v18 offset:17408
    ds_read_b128 v[180:183], v19 offset:1088
    v_mfma_f32_16x16x32_bf16 v[212:215], v[196:199], v[44:47], 0
    s_mov_b32 s56, 1572864
    s_add_u32 m0, s54, 81920
    s_nop 0
    buffer_load_dwordx4 v10, s[28:31], s56 offen lds
    s_mov_b32 s57, 28672
    buffer_load_dwordx4 v[80:83], v12, s[32:35], s57 offen offset:0
    s_mov_b32 s56, 1638400
    s_add_u32 m0, s54, 0
    s_nop 0
    buffer_load_dwordx4 v10, s[28:31], s56 offen lds
    s_mov_b32 s57, 28672
    buffer_load_dwordx4 v[84:87], v12, s[32:35], s57 offen offset:1024
    v_add_f32 v220, 0x358637bd, v204
    v_add_f32 v221, 0x358637bd, v212
    v_rcp_f32 v220, v220
    v_rcp_f32 v221, v221

    v_mul_f32 v200, v200, v220
    v_mul_f32 v201, v201, v220
    v_mul_f32 v202, v202, v220
    v_mul_f32 v203, v203, v220
    v_mul_f32 v208, v208, v221
    v_mul_f32 v209, v209, v221
    v_mul_f32 v210, v210, v221
    v_mul_f32 v211, v211, v221
    v_cvt_pk_bf16_f32 v216, v200, v201
    v_cvt_pk_bf16_f32 v217, v202, v203
    v_cvt_pk_bf16_f32 v218, v208, v209
    v_cvt_pk_bf16_f32 v219, v210, v211

    s_nop 1
    v_mfma_f32_16x16x32_bf16 v[152:155], v[104:107], v[216:219], v[152:155]
    v_mfma_f32_16x16x32_bf16 v[156:159], v[108:111], v[216:219], v[156:159]
    v_mfma_f32_16x16x32_bf16 v[160:163], v[112:115], v[216:219], v[160:163]
    v_mfma_f32_16x16x32_bf16 v[164:167], v[116:119], v[216:219], v[164:167]
    s_waitcnt vmcnt(15) lgkmcnt(12)
    v_mfma_f32_16x16x32_bf16 v[200:203], v[240:243], v[48:51], 0
    ds_read_b64_tr_b16 v[104:105], v13 offset:24576
    ds_read_b64_tr_b16 v[106:107], v13 offset:26624
    ds_read_b64_tr_b16 v[108:109], v14 offset:24576
    ds_read_b64_tr_b16 v[110:111], v14 offset:26624
    v_mfma_f32_16x16x32_bf16 v[204:207], v[244:247], v[48:51], 0
    ds_read_b64_tr_b16 v[112:113], v15 offset:24576
    ds_read_b64_tr_b16 v[114:115], v15 offset:26624
    ds_read_b64_tr_b16 v[116:117], v16 offset:24576
    v_mfma_f32_16x16x32_bf16 v[208:211], v[248:251], v[52:55], 0
    ds_read_b64_tr_b16 v[118:119], v16 offset:26624
    ds_read_b128 v[184:187], v18 offset:20480
    ds_read_b128 v[188:191], v19 offset:1280
    ds_read_b128 v[192:195], v18 offset:21504
    v_mfma_f32_16x16x32_bf16 v[212:215], v[252:255], v[52:55], 0
    ds_read_b128 v[196:199], v19 offset:1344
    s_mov_b32 s57, 40960
    buffer_load_dwordx4 v[40:43], v11, s[32:35], s57 offen
    s_mov_b32 s57, 43008
    buffer_load_dwordx4 v[44:47], v11, s[32:35], s57 offen
    v_add_f32 v220, 0x358637bd, v204
    s_nop 1
    v_add_f32 v221, 0x358637bd, v212
    v_rcp_f32 v220, v220
    v_rcp_f32 v221, v221

    v_mul_f32 v200, v200, v220
    v_mul_f32 v201, v201, v220
    v_mul_f32 v202, v202, v220
    v_mul_f32 v203, v203, v220
    v_mul_f32 v208, v208, v221
    v_mul_f32 v209, v209, v221
    v_mul_f32 v210, v210, v221
    v_mul_f32 v211, v211, v221
    v_cvt_pk_bf16_f32 v216, v200, v201
    v_cvt_pk_bf16_f32 v217, v202, v203
    v_cvt_pk_bf16_f32 v218, v208, v209
    v_cvt_pk_bf16_f32 v219, v210, v211

    s_nop 1
    v_mfma_f32_16x16x32_bf16 v[152:155], v[120:123], v[216:219], v[152:155]
    v_mfma_f32_16x16x32_bf16 v[156:159], v[124:127], v[216:219], v[156:159]
    v_mfma_f32_16x16x32_bf16 v[160:163], v[128:131], v[216:219], v[160:163]
    v_mfma_f32_16x16x32_bf16 v[164:167], v[132:135], v[216:219], v[164:167]
    s_waitcnt vmcnt(13) lgkmcnt(12)
    s_barrier
    v_mfma_f32_16x16x32_bf16 v[200:203], v[168:171], v[56:59], 0
    ds_read_b64_tr_b16 v[120:121], v13 offset:32768
    ds_read_b64_tr_b16 v[122:123], v13 offset:34816
    ds_read_b64_tr_b16 v[124:125], v14 offset:32768
    ds_read_b64_tr_b16 v[126:127], v14 offset:34816
    v_mfma_f32_16x16x32_bf16 v[204:207], v[172:175], v[56:59], 0
    ds_read_b64_tr_b16 v[128:129], v15 offset:32768
    ds_read_b64_tr_b16 v[130:131], v15 offset:34816
    ds_read_b64_tr_b16 v[132:133], v16 offset:32768
    ds_read_b64_tr_b16 v[134:135], v16 offset:34816
    v_mfma_f32_16x16x32_bf16 v[208:211], v[176:179], v[60:63], 0
    ds_read_b128 v[240:243], v18 offset:24576
    ds_read_b128 v[244:247], v19 offset:1536
    ds_read_b128 v[248:251], v18 offset:25600
    ds_read_b128 v[252:255], v19 offset:1600
    v_mfma_f32_16x16x32_bf16 v[212:215], v[180:183], v[60:63], 0
    s_mov_b32 s56, 1703936
    s_add_u32 m0, s54, 8192
    s_nop 0
    buffer_load_dwordx4 v10, s[28:31], s56 offen lds
    s_mov_b32 s57, 45056
    buffer_load_dwordx4 v[48:51], v11, s[32:35], s57 offen
    s_mov_b32 s56, 1769472
    s_add_u32 m0, s54, 16384
    s_nop 0
    buffer_load_dwordx4 v10, s[28:31], s56 offen lds
    s_mov_b32 s57, 47104
    buffer_load_dwordx4 v[52:55], v11, s[32:35], s57 offen
    v_add_f32 v220, 0x358637bd, v204
    v_add_f32 v221, 0x358637bd, v212
    v_rcp_f32 v220, v220
    v_rcp_f32 v221, v221

    v_mul_f32 v200, v200, v220
    v_mul_f32 v201, v201, v220
    v_mul_f32 v202, v202, v220
    v_mul_f32 v203, v203, v220
    v_mul_f32 v208, v208, v221
    v_mul_f32 v209, v209, v221
    v_mul_f32 v210, v210, v221
    v_mul_f32 v211, v211, v221
    v_cvt_pk_bf16_f32 v216, v200, v201
    v_cvt_pk_bf16_f32 v217, v202, v203
    v_cvt_pk_bf16_f32 v218, v208, v209
    v_cvt_pk_bf16_f32 v219, v210, v211

    s_nop 1
    v_mfma_f32_16x16x32_bf16 v[152:155], v[88:91], v[216:219], v[152:155]
    v_mfma_f32_16x16x32_bf16 v[156:159], v[92:95], v[216:219], v[156:159]
    v_mfma_f32_16x16x32_bf16 v[160:163], v[96:99], v[216:219], v[160:163]
    v_mfma_f32_16x16x32_bf16 v[164:167], v[100:103], v[216:219], v[164:167]
    s_waitcnt vmcnt(13) lgkmcnt(12)
    v_mfma_f32_16x16x32_bf16 v[200:203], v[184:187], v[64:67], 0
    ds_read_b64_tr_b16 v[88:89], v13 offset:40960
    ds_read_b64_tr_b16 v[90:91], v13 offset:43008
    ds_read_b64_tr_b16 v[92:93], v14 offset:40960
    ds_read_b64_tr_b16 v[94:95], v14 offset:43008
    v_mfma_f32_16x16x32_bf16 v[204:207], v[188:191], v[64:67], 0
    ds_read_b64_tr_b16 v[96:97], v15 offset:40960
    ds_read_b64_tr_b16 v[98:99], v15 offset:43008
    ds_read_b64_tr_b16 v[100:101], v16 offset:40960
    v_mfma_f32_16x16x32_bf16 v[208:211], v[192:195], v[68:71], 0
    ds_read_b64_tr_b16 v[102:103], v16 offset:43008
    ds_read_b128 v[168:171], v18 offset:28672
    ds_read_b128 v[172:175], v19 offset:1792
    ds_read_b128 v[176:179], v18 offset:29696
    v_mfma_f32_16x16x32_bf16 v[212:215], v[196:199], v[68:71], 0
    ds_read_b128 v[180:183], v19 offset:1856
    s_mov_b32 s57, 49152
    buffer_load_dwordx4 v[56:59], v11, s[32:35], s57 offen
    s_mov_b32 s57, 51200
    buffer_load_dwordx4 v[60:63], v11, s[32:35], s57 offen
    v_add_f32 v220, 0x358637bd, v204
    s_nop 1
    v_add_f32 v221, 0x358637bd, v212
    v_rcp_f32 v220, v220
    v_rcp_f32 v221, v221

    v_mul_f32 v200, v200, v220
    v_mul_f32 v201, v201, v220
    v_mul_f32 v202, v202, v220
    v_mul_f32 v203, v203, v220
    v_mul_f32 v208, v208, v221
    v_mul_f32 v209, v209, v221
    v_mul_f32 v210, v210, v221
    v_mul_f32 v211, v211, v221
    v_cvt_pk_bf16_f32 v216, v200, v201
    v_cvt_pk_bf16_f32 v217, v202, v203
    v_cvt_pk_bf16_f32 v218, v208, v209
    v_cvt_pk_bf16_f32 v219, v210, v211

    s_nop 1
    v_mfma_f32_16x16x32_bf16 v[152:155], v[104:107], v[216:219], v[152:155]
    v_mfma_f32_16x16x32_bf16 v[156:159], v[108:111], v[216:219], v[156:159]
    v_mfma_f32_16x16x32_bf16 v[160:163], v[112:115], v[216:219], v[160:163]
    v_mfma_f32_16x16x32_bf16 v[164:167], v[116:119], v[216:219], v[164:167]
    s_waitcnt vmcnt(12) lgkmcnt(12)
    s_barrier
    v_mfma_f32_16x16x32_bf16 v[200:203], v[240:243], v[72:75], 0
    ds_read_b64_tr_b16 v[104:105], v13 offset:49152
    ds_read_b64_tr_b16 v[106:107], v13 offset:51200
    ds_read_b64_tr_b16 v[108:109], v14 offset:49152
    v_mfma_f32_16x16x32_bf16 v[204:207], v[244:247], v[72:75], 0
    ds_read_b64_tr_b16 v[110:111], v14 offset:51200
    ds_read_b64_tr_b16 v[112:113], v15 offset:49152
    v_mfma_f32_16x16x32_bf16 v[208:211], v[248:251], v[76:79], 0
    ds_read_b64_tr_b16 v[114:115], v15 offset:51200
    ds_read_b64_tr_b16 v[116:117], v16 offset:49152
    ds_read_b64_tr_b16 v[118:119], v16 offset:51200
    v_mfma_f32_16x16x32_bf16 v[212:215], v[252:255], v[76:79], 0
    s_mov_b32 s57, 53248
    buffer_load_dwordx4 v[64:67], v11, s[32:35], s57 offen
    s_mov_b32 s57, 55296
    buffer_load_dwordx4 v[68:71], v11, s[32:35], s57 offen
    v_add_f32 v220, 0x358637bd, v204
    s_nop 2
    v_add_f32 v221, 0x358637bd, v212
    v_rcp_f32 v220, v220
    v_rcp_f32 v221, v221

    v_mul_f32 v200, v200, v220
    v_mul_f32 v201, v201, v220
    v_mul_f32 v202, v202, v220
    v_mul_f32 v203, v203, v220
    v_mul_f32 v208, v208, v221
    v_mul_f32 v209, v209, v221
    v_mul_f32 v210, v210, v221
    v_mul_f32 v211, v211, v221
    v_cvt_pk_bf16_f32 v216, v200, v201
    v_cvt_pk_bf16_f32 v217, v202, v203
    v_cvt_pk_bf16_f32 v218, v208, v209
    v_cvt_pk_bf16_f32 v219, v210, v211

    s_nop 1
    v_mfma_f32_16x16x32_bf16 v[152:155], v[120:123], v[216:219], v[152:155]
    v_mfma_f32_16x16x32_bf16 v[156:159], v[124:127], v[216:219], v[156:159]
    v_mfma_f32_16x16x32_bf16 v[160:163], v[128:131], v[216:219], v[160:163]
    v_mfma_f32_16x16x32_bf16 v[164:167], v[132:135], v[216:219], v[164:167]
    s_waitcnt vmcnt(10) lgkmcnt(8)
    v_mfma_f32_16x16x32_bf16 v[200:203], v[168:171], v[80:83], 0
    ds_read_b64_tr_b16 v[120:121], v13 offset:57344
    ds_read_b64_tr_b16 v[122:123], v13 offset:59392
    v_mfma_f32_16x16x32_bf16 v[204:207], v[172:175], v[80:83], 0
    ds_read_b64_tr_b16 v[124:125], v14 offset:57344
    ds_read_b64_tr_b16 v[126:127], v14 offset:59392
    v_mfma_f32_16x16x32_bf16 v[208:211], v[176:179], v[84:87], 0
    ds_read_b64_tr_b16 v[128:129], v15 offset:57344
    ds_read_b64_tr_b16 v[130:131], v15 offset:59392
    v_mfma_f32_16x16x32_bf16 v[212:215], v[180:183], v[84:87], 0
    ds_read_b64_tr_b16 v[132:133], v16 offset:57344
    ds_read_b64_tr_b16 v[134:135], v16 offset:59392
    v_add_f32 v220, 0x358637bd, v204
    s_nop 4
    v_add_f32 v221, 0x358637bd, v212
    v_rcp_f32 v220, v220
    v_rcp_f32 v221, v221

    v_mul_f32 v200, v200, v220
    v_mul_f32 v201, v201, v220
    v_mul_f32 v202, v202, v220
    v_mul_f32 v203, v203, v220
    v_mul_f32 v208, v208, v221
    v_mul_f32 v209, v209, v221
    v_mul_f32 v210, v210, v221
    v_mul_f32 v211, v211, v221
    v_cvt_pk_bf16_f32 v216, v200, v201
    v_cvt_pk_bf16_f32 v217, v202, v203
    v_cvt_pk_bf16_f32 v218, v208, v209
    v_cvt_pk_bf16_f32 v219, v210, v211

    s_nop 1
    v_mfma_f32_16x16x32_bf16 v[152:155], v[88:91], v[216:219], v[152:155]
    v_mfma_f32_16x16x32_bf16 v[156:159], v[92:95], v[216:219], v[156:159]
    v_mfma_f32_16x16x32_bf16 v[160:163], v[96:99], v[216:219], v[160:163]
    v_mfma_f32_16x16x32_bf16 v[164:167], v[100:103], v[216:219], v[164:167]
    s_waitcnt vmcnt(9) lgkmcnt(8)
    s_barrier
    v_mfma_f32_16x16x32_bf16 v[136:139], v[104:107], v[40:43], v[136:139]
    ds_read_b64_tr_b16 v[88:89], v236 offset:0
    ds_read_b64_tr_b16 v[90:91], v236 offset:2048
    v_mfma_f32_16x16x32_bf16 v[140:143], v[108:111], v[40:43], v[140:143]
    ds_read_b64_tr_b16 v[92:93], v237 offset:0
    ds_read_b64_tr_b16 v[94:95], v237 offset:2048
    v_mfma_f32_16x16x32_bf16 v[144:147], v[112:115], v[40:43], v[144:147]
    ds_read_b64_tr_b16 v[96:97], v238 offset:0
    ds_read_b64_tr_b16 v[98:99], v238 offset:2048
    v_mfma_f32_16x16x32_bf16 v[148:151], v[116:119], v[40:43], v[148:151]
    ds_read_b64_tr_b16 v[100:101], v239 offset:0
    ds_read_b64_tr_b16 v[102:103], v239 offset:2048
    s_waitcnt vmcnt(8) lgkmcnt(8)
    v_mfma_f32_16x16x32_bf16 v[136:139], v[120:123], v[44:47], v[136:139]
    ds_read_b64_tr_b16 v[104:105], v236 offset:8192
    ds_read_b64_tr_b16 v[106:107], v236 offset:10240
    v_mfma_f32_16x16x32_bf16 v[140:143], v[124:127], v[44:47], v[140:143]
    ds_read_b64_tr_b16 v[108:109], v237 offset:8192
    ds_read_b64_tr_b16 v[110:111], v237 offset:10240
    v_mfma_f32_16x16x32_bf16 v[144:147], v[128:131], v[44:47], v[144:147]
    ds_read_b64_tr_b16 v[112:113], v238 offset:8192
    ds_read_b64_tr_b16 v[114:115], v238 offset:10240
    v_mfma_f32_16x16x32_bf16 v[148:151], v[132:135], v[44:47], v[148:151]
    ds_read_b64_tr_b16 v[116:117], v239 offset:8192
    ds_read_b64_tr_b16 v[118:119], v239 offset:10240
    s_waitcnt vmcnt(6) lgkmcnt(8)
    s_barrier
    v_mfma_f32_16x16x32_bf16 v[136:139], v[88:91], v[48:51], v[136:139]
    ds_read_b64_tr_b16 v[120:121], v236 offset:16384
    ds_read_b64_tr_b16 v[122:123], v236 offset:18432
    v_mfma_f32_16x16x32_bf16 v[140:143], v[92:95], v[48:51], v[140:143]
    ds_read_b64_tr_b16 v[124:125], v237 offset:16384
    ds_read_b64_tr_b16 v[126:127], v237 offset:18432
    v_mfma_f32_16x16x32_bf16 v[144:147], v[96:99], v[48:51], v[144:147]
    ds_read_b64_tr_b16 v[128:129], v238 offset:16384
    ds_read_b64_tr_b16 v[130:131], v238 offset:18432
    v_mfma_f32_16x16x32_bf16 v[148:151], v[100:103], v[48:51], v[148:151]
    ds_read_b64_tr_b16 v[132:133], v239 offset:16384
    ds_read_b64_tr_b16 v[134:135], v239 offset:18432
    s_waitcnt vmcnt(4) lgkmcnt(8)
    v_mfma_f32_16x16x32_bf16 v[136:139], v[104:107], v[52:55], v[136:139]
    ds_read_b64_tr_b16 v[88:89], v13 offset:0
    ds_read_b64_tr_b16 v[90:91], v13 offset:2048
    v_mfma_f32_16x16x32_bf16 v[140:143], v[108:111], v[52:55], v[140:143]
    ds_read_b64_tr_b16 v[92:93], v14 offset:0
    ds_read_b64_tr_b16 v[94:95], v14 offset:2048
    v_mfma_f32_16x16x32_bf16 v[144:147], v[112:115], v[52:55], v[144:147]
    ds_read_b64_tr_b16 v[96:97], v15 offset:0
    ds_read_b64_tr_b16 v[98:99], v15 offset:2048
    v_mfma_f32_16x16x32_bf16 v[148:151], v[116:119], v[52:55], v[148:151]
    ds_read_b64_tr_b16 v[100:101], v16 offset:0
    ds_read_b64_tr_b16 v[102:103], v16 offset:2048
    s_waitcnt vmcnt(3) lgkmcnt(8)
    s_barrier
    v_mfma_f32_16x16x32_bf16 v[136:139], v[120:123], v[56:59], v[136:139]
    ds_read_b64_tr_b16 v[104:105], v13 offset:8192
    ds_read_b64_tr_b16 v[106:107], v13 offset:10240
    v_mfma_f32_16x16x32_bf16 v[140:143], v[124:127], v[56:59], v[140:143]
    ds_read_b64_tr_b16 v[108:109], v14 offset:8192
    ds_read_b64_tr_b16 v[110:111], v14 offset:10240
    v_mfma_f32_16x16x32_bf16 v[144:147], v[128:131], v[56:59], v[144:147]
    ds_read_b64_tr_b16 v[112:113], v15 offset:8192
    ds_read_b64_tr_b16 v[114:115], v15 offset:10240
    v_mfma_f32_16x16x32_bf16 v[148:151], v[132:135], v[56:59], v[148:151]
    ds_read_b64_tr_b16 v[116:117], v16 offset:8192
    ds_read_b64_tr_b16 v[118:119], v16 offset:10240
    s_waitcnt vmcnt(2) lgkmcnt(8)
    v_mfma_f32_16x16x32_bf16 v[136:139], v[88:91], v[60:63], v[136:139]
    ds_read_b64_tr_b16 v[120:121], v13 offset:16384
    ds_read_b64_tr_b16 v[122:123], v13 offset:18432
    v_mfma_f32_16x16x32_bf16 v[140:143], v[92:95], v[60:63], v[140:143]
    ds_read_b64_tr_b16 v[124:125], v14 offset:16384
    ds_read_b64_tr_b16 v[126:127], v14 offset:18432
    v_mfma_f32_16x16x32_bf16 v[144:147], v[96:99], v[60:63], v[144:147]
    ds_read_b64_tr_b16 v[128:129], v15 offset:16384
    ds_read_b64_tr_b16 v[130:131], v15 offset:18432
    v_mfma_f32_16x16x32_bf16 v[148:151], v[100:103], v[60:63], v[148:151]
    ds_read_b64_tr_b16 v[132:133], v16 offset:16384
    ds_read_b64_tr_b16 v[134:135], v16 offset:18432
    s_waitcnt vmcnt(1) lgkmcnt(8)
    s_barrier
    v_mfma_f32_16x16x32_bf16 v[136:139], v[104:107], v[64:67], v[136:139]
    v_mfma_f32_16x16x32_bf16 v[140:143], v[108:111], v[64:67], v[140:143]
    v_mfma_f32_16x16x32_bf16 v[144:147], v[112:115], v[64:67], v[144:147]
    v_mfma_f32_16x16x32_bf16 v[148:151], v[116:119], v[64:67], v[148:151]
    s_waitcnt vmcnt(0) lgkmcnt(0)
    v_mfma_f32_16x16x32_bf16 v[136:139], v[120:123], v[68:71], v[136:139]
    v_mfma_f32_16x16x32_bf16 v[140:143], v[124:127], v[68:71], v[140:143]
    v_mfma_f32_16x16x32_bf16 v[144:147], v[128:131], v[68:71], v[144:147]
    v_mfma_f32_16x16x32_bf16 v[148:151], v[132:135], v[68:71], v[148:151]
    s_nop 4
    ds_write_b128 v235, v[136:139] offset:0
    ds_write_b128 v235, v[152:155] offset:17408
    ds_write_b128 v235, v[140:143] offset:64
    ds_write_b128 v235, v[156:159] offset:17472
    ds_write_b128 v235, v[144:147] offset:128
    ds_write_b128 v235, v[160:163] offset:17536
    ds_write_b128 v235, v[148:151] offset:192
    ds_write_b128 v235, v[164:167] offset:17600
    s_waitcnt lgkmcnt(0)
    s_barrier
    ds_read_b128 v[40:43], v234 offset:0
    ds_read_b128 v[44:47], v234 offset:16
    ds_read_b128 v[48:51], v234 offset:17408
    ds_read_b128 v[52:55], v234 offset:17424
    ds_read_b128 v[56:59], v234 offset:34816
    ds_read_b128 v[60:63], v234 offset:34832
    ds_read_b128 v[64:67], v234 offset:52224
    ds_read_b128 v[68:71], v234 offset:52240
    s_waitcnt lgkmcnt(0)
    v_lshlrev_b32 v72, 16, v32
    v_and_b32 v73, 0xffff0000, v32
    v_lshlrev_b32 v80, 16, v28
    v_and_b32 v81, 0xffff0000, v28

    v_lshlrev_b32 v74, 16, v33
    v_and_b32 v75, 0xffff0000, v33
    v_lshlrev_b32 v82, 16, v29
    v_and_b32 v83, 0xffff0000, v29

    v_lshlrev_b32 v76, 16, v34
    v_and_b32 v77, 0xffff0000, v34
    v_lshlrev_b32 v84, 16, v30
    v_and_b32 v85, 0xffff0000, v30

    v_lshlrev_b32 v78, 16, v35
    v_and_b32 v79, 0xffff0000, v35
    v_lshlrev_b32 v86, 16, v31
    v_and_b32 v87, 0xffff0000, v31

    v_add_f32 v40, v40, v56
    v_add_f32 v41, v41, v57
    v_add_f32 v42, v42, v58
    v_add_f32 v43, v43, v59
    v_add_f32 v44, v44, v60
    v_add_f32 v45, v45, v61
    v_add_f32 v46, v46, v62
    v_add_f32 v47, v47, v63
    v_add_f32 v48, v48, v64
    v_add_f32 v49, v49, v65
    v_add_f32 v50, v50, v66
    v_add_f32 v51, v51, v67
    v_add_f32 v52, v52, v68
    v_add_f32 v53, v53, v69
    v_add_f32 v54, v54, v70
    v_add_f32 v55, v55, v71
    v_add_f32 v40, v40, v72
    v_add_f32 v41, v41, v73
    v_add_f32 v42, v42, v74
    v_add_f32 v43, v43, v75
    v_add_f32 v44, v44, v76
    v_add_f32 v45, v45, v77
    v_add_f32 v46, v46, v78
    v_add_f32 v47, v47, v79
    v_mul_f32_e64 v88, -v40, s55
    v_mul_f32_e64 v89, -v41, s55
    v_mul_f32_e64 v90, -v42, s55
    v_mul_f32_e64 v91, -v43, s55
    v_mul_f32_e64 v92, -v44, s55
    v_mul_f32_e64 v93, -v45, s55
    v_mul_f32_e64 v94, -v46, s55
    v_mul_f32_e64 v95, -v47, s55
    v_exp_f32 v88, v88
    v_exp_f32 v89, v89
    v_exp_f32 v90, v90
    v_exp_f32 v91, v91
    v_exp_f32 v92, v92
    v_exp_f32 v93, v93
    v_exp_f32 v94, v94
    v_exp_f32 v95, v95
    v_add_f32 v88, 1.0, v88
    v_add_f32 v89, 1.0, v89
    v_add_f32 v90, 1.0, v90
    v_add_f32 v91, 1.0, v91
    v_add_f32 v92, 1.0, v92
    v_add_f32 v93, 1.0, v93
    v_add_f32 v94, 1.0, v94
    v_add_f32 v95, 1.0, v95
    v_rcp_f32 v88, v88
    v_rcp_f32 v89, v89
    v_rcp_f32 v90, v90
    v_rcp_f32 v91, v91
    v_rcp_f32 v92, v92
    v_rcp_f32 v93, v93
    v_rcp_f32 v94, v94
    v_rcp_f32 v95, v95
    v_mul_f32 v40, v40, v88
    v_mul_f32 v41, v41, v89
    v_mul_f32 v42, v42, v90
    v_mul_f32 v43, v43, v91
    v_mul_f32 v44, v44, v92
    v_mul_f32 v45, v45, v93
    v_mul_f32 v46, v46, v94
    v_mul_f32 v47, v47, v95
    v_fma_f32 v40, v40, v48, v80
    v_fma_f32 v41, v41, v49, v81
    v_fma_f32 v42, v42, v50, v82
    v_fma_f32 v43, v43, v51, v83
    v_fma_f32 v44, v44, v52, v84
    v_fma_f32 v45, v45, v53, v85
    v_fma_f32 v46, v46, v54, v86
    v_fma_f32 v47, v47, v55, v87
    v_cvt_pk_bf16_f32 v96, v40, v41
    v_cvt_pk_bf16_f32 v97, v42, v43
    v_cvt_pk_bf16_f32 v98, v44, v45
    v_cvt_pk_bf16_f32 v99, v46, v47
    buffer_store_dwordx4 v[96:99], v232, s[64:67], 0 offen
K2_END:
    s_endpgm
CODE_END:
.section .rodata,"a"
.p2align 6
.amdhsa_kernel k1_kernel
  .amdhsa_next_free_vgpr 256
  .amdhsa_next_free_sgpr 102
  .amdhsa_accum_offset 256
  .amdhsa_group_segment_fixed_size 0
  .amdhsa_kernarg_size 96
  .amdhsa_user_sgpr_count 2
  .amdhsa_user_sgpr_kernarg_segment_ptr 1
  .amdhsa_system_sgpr_workgroup_id_x 1
.end_amdhsa_kernel
.p2align 6
.amdhsa_kernel k2_kernel
  .amdhsa_next_free_vgpr 256
  .amdhsa_next_free_sgpr 102
  .amdhsa_accum_offset 256
  .amdhsa_group_segment_fixed_size 0
  .amdhsa_kernarg_size 96
  .amdhsa_user_sgpr_count 2
  .amdhsa_user_sgpr_kernarg_segment_ptr 1
  .amdhsa_system_sgpr_workgroup_id_x 1
.end_amdhsa_kernel
```
